```python
import torch

def _softmax(x, axis=-1):
    return torch.softmax(x, dim=axis)
def _gelu(x):
    return torch.nn.functional.gelu(x, approximate="tanh")
def _silu(x):
    return torch.nn.functional.silu(x)
def _sigmoid(x):
    return torch.sigmoid(x)
def _layernorm(x, axis=-1, eps=1e-5):
    m = x.mean(dim=axis, keepdim=True)
    v = x.var(dim=axis, keepdim=True, unbiased=False)
    return (x - m) / torch.sqrt(v + eps)
def _scatter_add(tgt, idx, src, axis=0):
    return tgt.clone().index_add_(axis, idx, src)
def _segment_sum(src, seg, n):
    out = torch.zeros((n,) + src.shape[1:], dtype=src.dtype)
    return out.index_add_(0, seg, src)
def _pad(x, pw):
    flat = tuple(v for pair in reversed(pw) for v in pair)
    return torch.nn.functional.pad(x, flat)

kernel_name = 'interleave_layers__linear_attn_block__dense_activation_silu__prompt'

def setup_inputs():

    _w = (lambda a: (lambda t: t.to(torch.bfloat16) if t.is_floating_point() else t)(torch.as_tensor(a)))
    def _A_setup():
        B, S, D = 1, 2048, 512
        return {
            "x": _w((lambda *s: torch.randn(*s, dtype=torch.bfloat16) * 0.05)(B, S, D)),
            "wqkv": _w((lambda *s: torch.randn(*s, dtype=torch.bfloat16) * 0.05)(D, 3 * D)),
            "wo": _w((lambda *s: torch.randn(*s, dtype=torch.bfloat16) * 0.05)(D, D)),
        }
    _A_in = _A_setup()

    def _B_setup():
        B, S, D, F = 1, 2048, 512, 1792
        return {
            "x": _w((lambda *s: torch.randn(*s, dtype=torch.bfloat16) * 0.05)(B, S, D)),
            "w1": _w((lambda *s: torch.randn(*s, dtype=torch.bfloat16) * 0.8)(D, F) * (D ** -0.5)),
            "w2": _w((lambda *s: torch.randn(*s, dtype=torch.bfloat16) * 0.8)(F, D) * (F ** -0.5)),
        }
    _B_in = _B_setup()

    return {
        "A_x": _A_in["x"],
        "A_wqkv": _A_in["wqkv"],
        "A_wo": _A_in["wo"],
        "B_x": _B_in["x"],
        "B_w1": _B_in["w1"],
        "B_w2": _B_in["w2"],
    }

def reference(A_x, A_wqkv, A_wo, B_x, B_w1, B_w2):
    def _A_ref(x, wqkv, wo):
        B, S, D = x.shape
        H = 32; Dh = D // H
        qkv = (lambda x, *d: x.permute(*d))((x @ wqkv).reshape(B, S, 3, H, Dh), 2, 0, 3, 1, 4)
        q, k, v = qkv[0], qkv[1], qkv[2]
        phi = lambda t: torch.where(t > 0, t + 1, torch.exp(t)) + 1e-6
        pq, pk = phi(q), phi(k)
        kv = torch.einsum("bhsd,bhse->bhde", pk, v)
        z = torch.einsum("bhsd->bhd", pk)
        num = torch.einsum("bhqd,bhde->bhqe", pq, kv)
        den = torch.einsum("bhqd,bhd->bhq", pq, z)[..., None] + 1e-6
        o = num / den
        return (lambda x, *d: x.permute(*d))(o, 0, 2, 1, 3).reshape(B, S, D) @ wo

    def _B_ref(x, w1, w2):
        h = torch.einsum("bsd,df->bsf", x, w1)
        h = _silu(h)
        out = torch.einsum("bsf,fd->bsd", h, w2)
        return out

    x = A_x
    x = x + _A_ref(_layernorm(x, axis=-1), A_wqkv, A_wo)
    x = x + _B_ref(_layernorm(x, axis=-1), B_w1, B_w2)
    x = x + _A_ref(_layernorm(x, axis=-1), A_wqkv, A_wo)
    x = x + _B_ref(_layernorm(x, axis=-1), B_w1, B_w2)
    return x
```

```asm
; @launch grid=(256,1,1) block=(512,1,1) lds=163840
.amdgcn_target "amdgcn-amd-amdhsa--gfx950"
.text
.globl interleave_layers__linear_attn_block__dense_activation_silu__prompt_kernel
.p2align 8
.type interleave_layers__linear_attn_block__dense_activation_silu__prompt_kernel,@function
interleave_layers__linear_attn_block__dense_activation_silu__prompt_kernel:
    s_cmp_ge_u32 s2, 256
    s_cbranch_scc1 Lend_main
    s_load_dwordx2 s[4:5], s[0:1], 0
    s_mov_b32 s6, 2097152
    s_mov_b32 s7, 131072
    s_load_dwordx2 s[8:9], s[0:1], 8
    s_mov_b32 s10, 1572864
    s_mov_b32 s11, 131072
    s_load_dwordx2 s[12:13], s[0:1], 16
    s_mov_b32 s14, 524288
    s_mov_b32 s15, 131072
    s_load_dwordx2 s[16:17], s[0:1], 32
    s_mov_b32 s18, 1835008
    s_mov_b32 s19, 131072
    s_load_dwordx2 s[20:21], s[0:1], 40
    s_mov_b32 s22, 1835008
    s_mov_b32 s23, 131072
    s_load_dwordx2 s[24:25], s[0:1], 48
    s_mov_b32 s26, 2097152
    s_mov_b32 s27, 131072
    s_load_dwordx2 s[28:29], s[0:1], 56
    s_mov_b32 s30, 256
    s_mov_b32 s31, 131072
    s_load_dwordx2 s[32:33], s[0:1], 64
    s_mov_b32 s34, 268435456
    s_mov_b32 s35, 131072
    v_and_b32 v1, 63, v0
    v_and_b32 v2, 15, v0
    v_bfe_u32 v3, v0, 4, 2
    v_lshlrev_b32 v4, 4, v1
    v_lshrrev_b32 v5, 6, v0
    s_nop 0
    v_readfirstlane_b32 s36, v5
    s_and_b32 s37, s2, 7
    s_lshr_b32 s38, s2, 3
    s_lshr_b32 s42, s37, 1
    s_lshl_b32 s42, s42, 2
    s_lshr_b32 s39, s38, 3
    s_add_u32 s42, s42, s39
    s_and_b32 s43, s37, 1
    s_lshl_b32 s43, s43, 3
    s_and_b32 s39, s38, 7
    s_add_u32 s43, s43, s39
    s_lshl_b32 s44, s42, 8
    s_add_u32 s44, s44, 0x1a20000
    s_lshl_b32 s45, s42, 2
    s_add_u32 s45, s45, 0x1a20080
    s_mov_b32 s46, 0x1a21000
    v_mov_b32 v9, 1
    v_mov_b32 v10, 0
    v_mov_b32 v5, 0x7ff00000
    v_cmp_eq_u32 vcc, 0, v0
    s_nop 1
    v_cndmask_b32 v11, v5, v10, vcc
    v_lshlrev_b32 v12, 8, v1
    v_cmp_gt_u32 vcc, 16, v1
    s_nop 1
    v_cndmask_b32 v12, v5, v12, vcc
    v_lshlrev_b32 v14, 2, v2
    v_lshlrev_b32 v15, 4, v3
    v_mov_b32 v16, 0x3f803f80
    v_mov_b32 v17, 0x3f803f80
    v_mov_b32 v18, 0x3f803f80
    v_mov_b32 v19, 0x3f803f80
    s_lshl_b32 s47, s2, 3
    s_add_u32 s47, s47, s36
    s_lshl_b32 s48, s38, 3
    s_add_u32 s48, s48, s36
    v_lshlrev_b32 v20, 7, v1
    v_cmp_gt_u32 vcc, 2, v1
    s_nop 1
    v_cndmask_b32 v20, v5, v20, vcc
    v_lshlrev_b32 v21, 7, v1
    v_cmp_gt_u32 vcc, 7, v1
    s_nop 1
    v_cndmask_b32 v21, v5, v21, vcc
    v_lshlrev_b32 v22, 7, v1
    v_cmp_gt_u32 vcc, 6, v1
    s_nop 1
    v_cndmask_b32 v22, v5, v22, vcc
    v_lshlrev_b32 v23, 7, v1
    v_cmp_gt_u32 vcc, 8, v1
    s_nop 1
    v_cndmask_b32 v23, v5, v23, vcc
    v_lshlrev_b32 v24, 7, v1
    v_cmp_gt_u32 vcc, 48, v1
    s_nop 1
    v_cndmask_b32 v24, v5, v24, vcc
    v_lshlrev_b32 v25, 7, v1
    v_cmp_gt_u32 vcc, 56, v1
    s_nop 1
    v_cndmask_b32 v25, v5, v25, vcc
    s_mov_b32 s50, 0x3fb8aa3b
    s_mov_b32 s51, 0x3fb8aa3b
    s_mov_b32 s52, 0xbfb8aa3b
    s_mov_b32 s53, 0xbfb8aa3b
    s_mov_b32 s54, 0x358637bd
    s_mov_b32 s55, 0x358637bd
    s_mov_b32 s56, 0x3f800000
    s_mov_b32 s57, 0x3f800000
    s_lshl_b32 s58, s36, 10
    s_lshl_b32 s61, s42, 3
    s_add_u32 s61, s61, s36
    s_and_b32 s62, s36, 1
    s_and_b32 s64, s43, 7
    s_lshr_b32 s39, s43, 3
    s_lshl_b32 s39, s39, 2
    s_lshl_b32 s63, s42, 3
    s_add_u32 s63, s63, s39
    s_lshr_b32 s39, s36, 1
    s_add_u32 s63, s63, s39
    s_lshl_b32 s65, s64, 1
    s_add_u32 s65, s65, s62
    v_lshrrev_b32 v5, 3, v1
    v_bfe_u32 v6, v1, 4, 2
    v_bfe_u32 v8, v1, 1, 2
    v_xor_b32 v6, v6, v8
    v_and_b32 v7, 1, v1
    v_lshlrev_b32 v7, 4, v7
    v_lshl_add_u32 v30, v6, 5, v7
    v_mul_u32_u24 v29, 3584, v5
    v_add_u32 v29, v29, v30
    v_lshl_add_u32 v30, v5, 10, v30
    v_mul_u32_u24 v28, 3072, v5
    v_lshrrev_b32 v8, 1, v6
    v_lshl_add_u32 v28, v8, 10, v28
    v_and_b32 v8, 1, v6
    v_lshl_add_u32 v28, v8, 5, v28
    v_add_u32 v28, v28, v7
    v_add_u32 v28, 1024, v28
    v_lshrrev_b32 v5, 2, v1
    v_bfe_u32 v6, v1, 4, 1
    v_bfe_u32 v8, v1, 1, 1
    v_xor_b32 v6, v6, v8
    v_mul_u32_u24 v31, 3072, v5
    v_lshl_add_u32 v31, v6, 5, v31
    v_add_u32 v31, v31, v7
    v_add_u32 v5, 0, v1
    v_mul_u32_u24 v6, 10923, v5
    v_lshrrev_b32 v6, 16, v6
    v_mul_u32_u24 v7, 6, v6
    v_sub_u32 v7, v5, v7
    v_mul_u32_u24 v32, 3584, v6
    v_lshl_add_u32 v32, v7, 4, v32
    v_add_u32 v32, 128, v32
    v_add_u32 v5, 64, v1
    v_mul_u32_u24 v6, 10923, v5
    v_lshrrev_b32 v6, 16, v6
    v_mul_u32_u24 v7, 6, v6
    v_sub_u32 v7, v5, v7
    v_mul_u32_u24 v33, 3584, v6
    v_lshl_add_u32 v33, v7, 4, v33
    v_add_u32 v33, 128, v33
    v_add_u32 v5, 128, v1
    v_mul_u32_u24 v6, 10923, v5
    v_lshrrev_b32 v6, 16, v6
    v_mul_u32_u24 v7, 6, v6
    v_sub_u32 v7, v5, v7
    v_mul_u32_u24 v34, 3584, v6
    v_lshl_add_u32 v34, v7, 4, v34
    v_add_u32 v34, 128, v34
    v_bfe_u32 v5, v1, 2, 4
    v_and_b32 v6, 3, v1
    v_lshlrev_b32 v6, 3, v6
    v_bfe_u32 v7, v5, 1, 2
    v_xor_b32 v35, 0, v7
    v_lshl_add_u32 v35, v35, 5, v6
    v_lshl_add_u32 v35, v5, 7, v35
    v_xor_b32 v36, 1, v7
    v_lshl_add_u32 v36, v36, 5, v6
    v_lshl_add_u32 v36, v5, 7, v36
    v_xor_b32 v37, 2, v7
    v_lshl_add_u32 v37, v37, 5, v6
    v_lshl_add_u32 v37, v5, 7, v37
    v_xor_b32 v38, 3, v7
    v_lshl_add_u32 v38, v38, 5, v6
    v_lshl_add_u32 v38, v5, 7, v38
    s_cmp_eq_u32 s62, 1
    s_cselect_b64 s[66:67], -1, 0
    v_cndmask_b32 v39, v35, v37, s[66:67]
    v_cndmask_b32 v40, v36, v38, s[66:67]
    v_cndmask_b32 v41, v37, v35, s[66:67]
    v_cndmask_b32 v42, v38, v36, s[66:67]
    v_bfe_u32 v7, v5, 2, 1
    v_xor_b32 v43, 0, v7
    v_lshl_add_u32 v43, v43, 5, v6
    v_lshl_add_u32 v43, v5, 6, v43
    v_xor_b32 v44, 1, v7
    v_lshl_add_u32 v44, v44, 5, v6
    v_lshl_add_u32 v44, v5, 6, v44
    v_mul_u32_u24 v45, 96, v5
    v_add_u32 v45, v45, v6
    s_lshr_b32 s39, s36, 1
    s_mul_i32 s68, s39, 458752
    s_lshl_b32 s39, s64, 7
    s_add_u32 s68, s68, s39
    s_lshl_b32 s69, s36, 11
    s_and_b32 s70, s36, 3
    s_mul_i32 s39, s62, 114688
    s_add_u32 s72, s68, s39
    s_lshl_b32 s39, s62, 14
    s_add_u32 s71, s68, s39
    s_lshl_b32 s39, s43, 6
    s_mul_i32 s74, s36, 24576
    s_add_u32 s74, s74, s39
    s_mul_i32 s75, s36, 49152
    s_add_u32 s75, s75, s39
    s_lshl_b32 s76, s36, 13
    s_lshl_b32 s39, s64, 7
    s_add_u32 s76, s76, s39
    s_mul_i32 s39, s43, 224
    s_mul_i32 s77, s36, 28672
    s_add_u32 s77, s77, s39
    s_mul_i32 s78, s36, 114688
    s_add_u32 s78, s78, s39
    s_mul_i32 s79, s36, 3072
    s_waitcnt lgkmcnt(0)
    s_mul_i32 s59, s47, 1024
    buffer_load_dword v13, v23, s[4:7], s59 offen
    s_mul_i32 s59, s47, 768
    buffer_load_dword v13, v22, s[8:11], s59 offen
    v_mov_b32 v48, 0
    v_mov_b32 v49, 0
    v_mov_b32 v50, 0
    v_mov_b32 v51, 0
    s_cmp_eq_u32 s43, 0
    s_cselect_b32 s80, 0, 0x7ff00000
    s_lshl_b32 s39, s42, 13
    s_add_u32 s39, s39, s58
    s_add_u32 s39, s39, 0x1a00000
    s_add_u32 s39, s39, s80
    buffer_store_dwordx4 v[48:51], v4, s[32:35], s39 offen sc1
    v_lshlrev_b32 v52, 4, v2
    s_add_u32 s39, s44, s80
    buffer_store_dwordx4 v[48:51], v52, s[32:35], s39 offen sc1
    s_add_u32 s39, s46, s80
    s_cmp_eq_u32 s42, 0
    s_cselect_b32 s39, s39, 0x7ff00000
    buffer_store_dwordx4 v[48:51], v52, s[32:35], s39 offen sc1
    s_mov_b32 s81, 0
    s_lshl_b32 s82, s36, 7
    s_add_u32 s82, s82, 153600
    v_lshrrev_b32 v5, 5, v1
    v_add_u32 v5, 0, v5
    v_and_b32 v6, 31, v1
    v_xor_b32 v6, v6, v5
    v_lshlrev_b32 v58, 10, v5
    v_lshl_add_u32 v58, v6, 4, v58
    v_lshrrev_b32 v5, 5, v1
    v_add_u32 v5, 2, v5
    v_and_b32 v6, 31, v1
    v_xor_b32 v6, v6, v5
    v_lshlrev_b32 v59, 10, v5
    v_lshl_add_u32 v59, v6, 4, v59
    v_lshrrev_b32 v5, 5, v1
    v_add_u32 v5, 4, v5
    v_and_b32 v6, 31, v1
    v_xor_b32 v6, v6, v5
    v_lshlrev_b32 v60, 10, v5
    v_lshl_add_u32 v60, v6, 4, v60
    v_lshrrev_b32 v5, 5, v1
    v_add_u32 v5, 6, v5
    v_and_b32 v6, 31, v1
    v_xor_b32 v6, v6, v5
    v_lshlrev_b32 v61, 10, v5
    v_lshl_add_u32 v61, v6, 4, v61
    v_lshrrev_b32 v5, 5, v1
    v_add_u32 v5, 8, v5
    v_and_b32 v6, 31, v1
    v_xor_b32 v6, v6, v5
    v_lshlrev_b32 v62, 10, v5
    v_lshl_add_u32 v62, v6, 4, v62
    v_lshrrev_b32 v5, 5, v1
    v_add_u32 v5, 10, v5
    v_and_b32 v6, 31, v1
    v_xor_b32 v6, v6, v5
    v_lshlrev_b32 v63, 10, v5
    v_lshl_add_u32 v63, v6, 4, v63
    v_lshrrev_b32 v5, 5, v1
    v_add_u32 v5, 12, v5
    v_and_b32 v6, 31, v1
    v_xor_b32 v6, v6, v5
    v_lshlrev_b32 v64, 10, v5
    v_lshl_add_u32 v64, v6, 4, v64
    v_lshrrev_b32 v5, 5, v1
    v_add_u32 v5, 14, v5
    v_and_b32 v6, 31, v1
    v_xor_b32 v6, v6, v5
    v_lshlrev_b32 v65, 10, v5
    v_lshl_add_u32 v65, v6, 4, v65
    s_lshl_b32 s83, s61, 14
    s_lshl_b32 s39, s62, 9
    s_add_u32 s83, s83, s39
    s_xor_b32 s84, s83, 16384
    s_lshl_b32 s85, s36, 13
    v_lshlrev_b32 v66, 9, v2
    v_and_b32 v5, 1, v3
    v_lshl_add_u32 v66, v5, 3, v66
    v_add_u32 v66, s85, v66
    v_lshrrev_b32 v5, 1, v3
    v_and_b32 v6, 3, v2
    v_add_u32 v7, 0, v5
    v_xor_b32 v7, v7, v6
    v_lshl_add_u32 v67, v7, 4, v66
    v_add_u32 v7, 2, v5
    v_xor_b32 v7, v7, v6
    v_lshl_add_u32 v68, v7, 4, v66
    v_bfe_u32 v8, v2, 2, 2
    v_xor_b32 v5, 0, v8
    v_lshl_add_u32 v69, v5, 6, v67
    v_lshl_add_u32 v70, v5, 6, v68
    v_xor_b32 v5, 1, v8
    v_lshl_add_u32 v71, v5, 6, v67
    v_lshl_add_u32 v72, v5, 6, v68
    v_xor_b32 v5, 2, v8
    v_lshl_add_u32 v73, v5, 6, v67
    v_lshl_add_u32 v74, v5, 6, v68
    v_xor_b32 v5, 3, v8
    v_lshl_add_u32 v75, v5, 6, v67
    v_lshl_add_u32 v76, v5, 6, v68
    s_add_u32 m0, s85, 0
    s_nop 0
    buffer_load_dwordx4 v58, s[4:7], s83 offen lds
    s_add_u32 m0, s85, 1024
    s_nop 0
    buffer_load_dwordx4 v59, s[4:7], s83 offen lds
    s_add_u32 m0, s85, 2048
    s_nop 0
    buffer_load_dwordx4 v60, s[4:7], s83 offen lds
    s_add_u32 m0, s85, 3072
    s_nop 0
    buffer_load_dwordx4 v61, s[4:7], s83 offen lds
    s_add_u32 m0, s85, 4096
    s_nop 0
    buffer_load_dwordx4 v62, s[4:7], s83 offen lds
    s_add_u32 m0, s85, 5120
    s_nop 0
    buffer_load_dwordx4 v63, s[4:7], s83 offen lds
    s_add_u32 m0, s85, 6144
    s_nop 0
    buffer_load_dwordx4 v64, s[4:7], s83 offen lds
    s_add_u32 m0, s85, 7168
    s_nop 0
    buffer_load_dwordx4 v65, s[4:7], s83 offen lds
    s_add_u32 m0, s58, 81920
    s_add_u32 s73, s74, 0
    buffer_load_dwordx4 v28, s[8:11], s73 offen lds
    s_add_u32 m0, s58, 90112
    s_add_u32 s73, s74, 196608
    buffer_load_dwordx4 v28, s[8:11], s73 offen lds
    s_add_u32 m0, s58, 98304
    s_add_u32 s73, s74, 393216
    buffer_load_dwordx4 v28, s[8:11], s73 offen lds
    s_add_u32 m0, s58, 106496
    s_add_u32 s73, s74, 589824
    buffer_load_dwordx4 v28, s[8:11], s73 offen lds
    s_add_u32 m0, s58, 114688
    s_add_u32 s73, s74, 786432
    buffer_load_dwordx4 v28, s[8:11], s73 offen lds
    s_add_u32 m0, s58, 122880
    s_add_u32 s73, s74, 983040
    buffer_load_dwordx4 v28, s[8:11], s73 offen lds
    s_add_u32 m0, s58, 131072
    s_add_u32 s73, s74, 1179648
    buffer_load_dwordx4 v28, s[8:11], s73 offen lds
    s_add_u32 m0, s58, 139264
    s_add_u32 s73, s74, 1376256
    buffer_load_dwordx4 v28, s[8:11], s73 offen lds
    v_lshrrev_b32 v5, 2, v1
    v_lshlrev_b32 v5, 10, v5
    v_and_b32 v6, 3, v1
    v_lshl_add_u32 v5, v6, 7, v5
    buffer_load_dword v13, v5, s[4:7], s84 offen
    v_mul_u32_u24 v5, 3072, v1
    s_mul_i32 s39, s36, 196608
    s_lshl_b32 s40, s43, 6
    s_add_u32 s39, s39, s40
    buffer_load_dword v13, v5, s[8:11], s39 offen
    s_waitcnt vmcnt(10)
    ds_read_b64 a[0:1], v69
    ds_read_b64 a[2:3], v70
    ds_read_b64 a[4:5], v71
    ds_read_b64 a[6:7], v72
    ds_read_b64 a[8:9], v73
    ds_read_b64 a[10:11], v74
    ds_read_b64 a[12:13], v75
    ds_read_b64 a[14:15], v76
    ds_read_b64 a[16:17], v69 offset:256
    ds_read_b64 a[18:19], v70 offset:256
    ds_read_b64 a[20:21], v71 offset:256
    ds_read_b64 a[22:23], v72 offset:256
    ds_read_b64 a[24:25], v73 offset:256
    ds_read_b64 a[26:27], v74 offset:256
    ds_read_b64 a[28:29], v75 offset:256
    ds_read_b64 a[30:31], v76 offset:256
    s_waitcnt lgkmcnt(0)
    s_add_u32 m0, s85, 0
    s_nop 0
    buffer_load_dwordx4 v58, s[4:7], s84 offen lds
    s_add_u32 m0, s85, 1024
    s_nop 0
    buffer_load_dwordx4 v59, s[4:7], s84 offen lds
    s_add_u32 m0, s85, 2048
    s_nop 0
    buffer_load_dwordx4 v60, s[4:7], s84 offen lds
    s_add_u32 m0, s85, 3072
    s_nop 0
    buffer_load_dwordx4 v61, s[4:7], s84 offen lds
    s_add_u32 m0, s85, 4096
    s_nop 0
    buffer_load_dwordx4 v62, s[4:7], s84 offen lds
    s_add_u32 m0, s85, 5120
    s_nop 0
    buffer_load_dwordx4 v63, s[4:7], s84 offen lds
    s_add_u32 m0, s85, 6144
    s_nop 0
    buffer_load_dwordx4 v64, s[4:7], s84 offen lds
    s_add_u32 m0, s85, 7168
    s_nop 0
    buffer_load_dwordx4 v65, s[4:7], s84 offen lds
    s_waitcnt vmcnt(0)
    ds_read_b64 a[32:33], v69
    ds_read_b64 a[34:35], v70
    ds_read_b64 a[36:37], v71
    ds_read_b64 a[38:39], v72
    ds_read_b64 a[40:41], v73
    ds_read_b64 a[42:43], v74
    ds_read_b64 a[44:45], v75
    ds_read_b64 a[46:47], v76
    ds_read_b64 a[48:49], v69 offset:256
    ds_read_b64 a[50:51], v70 offset:256
    ds_read_b64 a[52:53], v71 offset:256
    ds_read_b64 a[54:55], v72 offset:256
    ds_read_b64 a[56:57], v73 offset:256
    ds_read_b64 a[58:59], v74 offset:256
    ds_read_b64 a[60:61], v75 offset:256
    ds_read_b64 a[62:63], v76 offset:256
    s_waitcnt lgkmcnt(0)
    s_barrier
    s_lshl_b32 s39, s42, 2
    s_add_u32 s39, s39, s80
    buffer_store_dword v9, v11, s[28:31], s39 offen sc1
    s_add_u32 m0, s58, 0
    s_add_u32 s73, s75, 0
    buffer_load_dwordx4 v31, s[8:11], s73 offen lds
    s_add_u32 m0, s58, 8192
    s_add_u32 s73, s75, 393216
    buffer_load_dwordx4 v31, s[8:11], s73 offen lds
    s_add_u32 m0, s58, 16384
    s_add_u32 s73, s75, 786432
    buffer_load_dwordx4 v31, s[8:11], s73 offen lds
    s_add_u32 m0, s58, 24576
    s_add_u32 s73, s75, 1179648
    buffer_load_dwordx4 v31, s[8:11], s73 offen lds
    s_mul_i32 s59, s47, 256
    buffer_load_dword v13, v20, s[12:15], s59 offen
    s_mul_i32 s59, s47, 896
    buffer_load_dword v13, v21, s[16:19], s59 offen
    s_mul_i32 s59, s47, 896
    buffer_load_dword v13, v21, s[20:23], s59 offen
    v_mfma_f32_16x16x32_bf16 v[60:63], a[0:3], a[0:3], 0
    v_mfma_f32_16x16x32_bf16 v[68:71], v[16:19], a[0:3], 0
    v_mfma_f32_16x16x32_bf16 v[64:67], a[32:35], a[32:35], 0
    v_mfma_f32_16x16x32_bf16 v[72:75], v[16:19], a[32:35], 0
    v_mfma_f32_16x16x32_bf16 v[60:63], a[4:7], a[4:7], v[60:63]
    v_mfma_f32_16x16x32_bf16 v[68:71], v[16:19], a[4:7], v[68:71]
    v_mfma_f32_16x16x32_bf16 v[64:67], a[36:39], a[36:39], v[64:67]
    v_mfma_f32_16x16x32_bf16 v[72:75], v[16:19], a[36:39], v[72:75]
    v_mfma_f32_16x16x32_bf16 v[60:63], a[8:11], a[8:11], v[60:63]
    v_mfma_f32_16x16x32_bf16 v[68:71], v[16:19], a[8:11], v[68:71]
    v_mfma_f32_16x16x32_bf16 v[64:67], a[40:43], a[40:43], v[64:67]
    v_mfma_f32_16x16x32_bf16 v[72:75], v[16:19], a[40:43], v[72:75]
    v_mfma_f32_16x16x32_bf16 v[60:63], a[12:15], a[12:15], v[60:63]
    v_mfma_f32_16x16x32_bf16 v[68:71], v[16:19], a[12:15], v[68:71]
    v_mfma_f32_16x16x32_bf16 v[64:67], a[44:47], a[44:47], v[64:67]
    v_mfma_f32_16x16x32_bf16 v[72:75], v[16:19], a[44:47], v[72:75]
    v_mfma_f32_16x16x32_bf16 v[60:63], a[16:19], a[16:19], v[60:63]
    v_mfma_f32_16x16x32_bf16 v[68:71], v[16:19], a[16:19], v[68:71]
    v_mfma_f32_16x16x32_bf16 v[64:67], a[48:51], a[48:51], v[64:67]
    v_mfma_f32_16x16x32_bf16 v[72:75], v[16:19], a[48:51], v[72:75]
    v_mfma_f32_16x16x32_bf16 v[60:63], a[20:23], a[20:23], v[60:63]
    v_mfma_f32_16x16x32_bf16 v[68:71], v[16:19], a[20:23], v[68:71]
    v_mfma_f32_16x16x32_bf16 v[64:67], a[52:55], a[52:55], v[64:67]
    v_mfma_f32_16x16x32_bf16 v[72:75], v[16:19], a[52:55], v[72:75]
    v_mfma_f32_16x16x32_bf16 v[60:63], a[24:27], a[24:27], v[60:63]
    v_mfma_f32_16x16x32_bf16 v[68:71], v[16:19], a[24:27], v[68:71]
    v_mfma_f32_16x16x32_bf16 v[64:67], a[56:59], a[56:59], v[64:67]
    v_mfma_f32_16x16x32_bf16 v[72:75], v[16:19], a[56:59], v[72:75]
    v_mfma_f32_16x16x32_bf16 v[60:63], a[28:31], a[28:31], v[60:63]
    v_mfma_f32_16x16x32_bf16 v[68:71], v[16:19], a[28:31], v[68:71]
    v_mfma_f32_16x16x32_bf16 v[64:67], a[60:63], a[60:63], v[64:67]
    v_mfma_f32_16x16x32_bf16 v[72:75], v[16:19], a[60:63], v[72:75]
    s_lshl_b32 s39, s36, 8
    s_add_u32 s39, s39, 155648
    v_add_u32 v53, s39, v14
    v_and_b32 v5, 3, v1
    v_lshrrev_b32 v6, 2, v2
    v_cmp_eq_u32 vcc, 1, v5
    s_nop 1
    v_cndmask_b32 v60, v60, v61, vcc
    v_cmp_eq_u32 vcc, 2, v5
    s_nop 1
    v_cndmask_b32 v60, v60, v62, vcc
    v_cmp_eq_u32 vcc, 3, v5
    s_nop 1
    v_cndmask_b32 v60, v60, v63, vcc
    v_cmp_eq_u32 vcc, 1, v5
    s_nop 1
    v_cndmask_b32 v64, v64, v65, vcc
    v_cmp_eq_u32 vcc, 2, v5
    s_nop 1
    v_cndmask_b32 v64, v64, v66, vcc
    v_cmp_eq_u32 vcc, 3, v5
    s_nop 1
    v_cndmask_b32 v64, v64, v67, vcc
    v_cmp_eq_u32 vcc, v6, v3
    s_nop 1
    s_and_saveexec_b64 s[86:87], vcc
    ds_write_b32 v53, v68
    ds_write_b32 v53, v60 offset:64
    ds_write_b32 v53, v72 offset:128
    ds_write_b32 v53, v64 offset:192
    s_mov_b64 exec, s[86:87]
    s_waitcnt vmcnt(3)
    s_waitcnt lgkmcnt(0)
    s_barrier
    ds_read_b32 v54, v53
    ds_read_b32 v56, v53 offset:64
    s_xor_b32 s39, s39, 256
    v_add_u32 v53, s39, v14
    ds_read_b32 v55, v53 offset:128
    ds_read_b32 v57, v53 offset:192
    s_waitcnt lgkmcnt(0)
    v_add_f32 v54, v54, v55
    v_add_f32 v56, v56, v57
    v_mul_f32 v54, 0x3b000000, v54
    v_mul_f32 v56, 0x3b000000, v56
    v_fma_f32 v56, -v54, v54, v56
    v_max_f32 v56, 0, v56
    v_cvt_pk_bf16_f32 v7, v54, v56
    v_lshlrev_b32 v54, 16, v7
    v_and_b32 v56, 4294901760, v7
    v_add_f32 v56, 0x3727c5ac, v56
    v_cvt_pk_bf16_f32 v7, v56, v56
    v_lshlrev_b32 v56, 16, v7
    v_sqrt_f32 v56, v56
    s_nop 0
    v_cvt_pk_bf16_f32 v7, v56, v56
    v_lshlrev_b32 v56, 16, v7
    v_rcp_f32 v56, v56
    v_sub_f32 v54, 0, v54
    s_min_u32 s89, s36, 5
    v_add_u32 v76, 81920, v35
    s_mov_b32 s88, 4096
    s_mov_b32 s90, 2048
    s_cmp_lg_u32 s89, 1
    s_cbranch_scc1 Linterleave_layers__linear_attn_block__dense_activation_silu__prompt_kernel_0
    v_add_u32 v76, 81920, v36
Linterleave_layers__linear_attn_block__dense_activation_silu__prompt_kernel_0:
    s_cmp_lg_u32 s89, 2
    s_cbranch_scc1 Linterleave_layers__linear_attn_block__dense_activation_silu__prompt_kernel_1
    v_add_u32 v76, 81920, v37
Linterleave_layers__linear_attn_block__dense_activation_silu__prompt_kernel_1:
    s_cmp_lg_u32 s89, 3
    s_cbranch_scc1 Linterleave_layers__linear_attn_block__dense_activation_silu__prompt_kernel_2
    v_add_u32 v76, 81920, v38
Linterleave_layers__linear_attn_block__dense_activation_silu__prompt_kernel_2:
    s_cmp_lg_u32 s89, 4
    s_cbranch_scc1 Linterleave_layers__linear_attn_block__dense_activation_silu__prompt_kernel_3
    v_add_u32 v76, 0, v43
    s_mov_b32 s88, 2048
    s_mov_b32 s90, 1024
Linterleave_layers__linear_attn_block__dense_activation_silu__prompt_kernel_3:
    s_cmp_lg_u32 s89, 5
    s_cbranch_scc1 Linterleave_layers__linear_attn_block__dense_activation_silu__prompt_kernel_4
    v_add_u32 v76, 0, v44
    s_mov_b32 s88, 2048
    s_mov_b32 s90, 1024
Linterleave_layers__linear_attn_block__dense_activation_silu__prompt_kernel_4:
    s_nop 3
    v_add_u32 v77, s90, v76
    ds_read_b64_tr_b16 a[64:65], v76
    ds_read_b64_tr_b16 a[66:67], v77
    v_add_u32 v76, s88, v76
    v_add_u32 v77, s88, v77
    ds_read_b64_tr_b16 a[68:69], v76
    ds_read_b64_tr_b16 a[70:71], v77
    v_add_u32 v76, s88, v76
    v_add_u32 v77, s88, v77
    ds_read_b64_tr_b16 a[72:73], v76
    ds_read_b64_tr_b16 a[74:75], v77
    v_add_u32 v76, s88, v76
    v_add_u32 v77, s88, v77
    ds_read_b64_tr_b16 a[76:77], v76
    ds_read_b64_tr_b16 a[78:79], v77
    v_add_u32 v76, s88, v76
    v_add_u32 v77, s88, v77
    ds_read_b64_tr_b16 a[80:81], v76
    ds_read_b64_tr_b16 a[82:83], v77
    v_add_u32 v76, s88, v76
    v_add_u32 v77, s88, v77
    s_waitcnt lgkmcnt(8)
    v_mfma_f32_16x16x32_bf16 v[80:83], v[16:19], a[64:67], 0
    ds_read_b64_tr_b16 a[84:85], v76
    ds_read_b64_tr_b16 a[86:87], v77
    v_add_u32 v76, s88, v76
    v_add_u32 v77, s88, v77
    s_waitcnt lgkmcnt(8)
    v_mfma_f32_16x16x32_bf16 v[80:83], v[16:19], a[68:71], v[80:83]
    ds_read_b64_tr_b16 a[88:89], v76
    ds_read_b64_tr_b16 a[90:91], v77
    v_add_u32 v76, s88, v76
    v_add_u32 v77, s88, v77
    s_waitcnt lgkmcnt(8)
    v_mfma_f32_16x16x32_bf16 v[80:83], v[16:19], a[72:75], v[80:83]
    ds_read_b64_tr_b16 a[92:93], v76
    ds_read_b64_tr_b16 a[94:95], v77
    v_add_u32 v76, s88, v76
    v_add_u32 v77, s88, v77
    s_waitcnt lgkmcnt(8)
    v_mfma_f32_16x16x32_bf16 v[80:83], v[16:19], a[76:79], v[80:83]
    ds_read_b64_tr_b16 a[64:65], v76
    ds_read_b64_tr_b16 a[66:67], v77
    v_add_u32 v76, s88, v76
    v_add_u32 v77, s88, v77
    s_waitcnt lgkmcnt(8)
    v_mfma_f32_16x16x32_bf16 v[80:83], v[16:19], a[80:83], v[80:83]
    ds_read_b64_tr_b16 a[68:69], v76
    ds_read_b64_tr_b16 a[70:71], v77
    v_add_u32 v76, s88, v76
    v_add_u32 v77, s88, v77
    s_waitcnt lgkmcnt(8)
    v_mfma_f32_16x16x32_bf16 v[80:83], v[16:19], a[84:87], v[80:83]
    ds_read_b64_tr_b16 a[72:73], v76
    ds_read_b64_tr_b16 a[74:75], v77
    v_add_u32 v76, s88, v76
    v_add_u32 v77, s88, v77
    s_waitcnt lgkmcnt(8)
    v_mfma_f32_16x16x32_bf16 v[80:83], v[16:19], a[88:91], v[80:83]
    ds_read_b64_tr_b16 a[76:77], v76
    ds_read_b64_tr_b16 a[78:79], v77
    v_add_u32 v76, s88, v76
    v_add_u32 v77, s88, v77
    s_waitcnt lgkmcnt(8)
    v_mfma_f32_16x16x32_bf16 v[80:83], v[16:19], a[92:95], v[80:83]
    ds_read_b64_tr_b16 a[80:81], v76
    ds_read_b64_tr_b16 a[82:83], v77
    v_add_u32 v76, s88, v76
    v_add_u32 v77, s88, v77
    s_waitcnt lgkmcnt(8)
    v_mfma_f32_16x16x32_bf16 v[80:83], v[16:19], a[64:67], v[80:83]
    ds_read_b64_tr_b16 a[84:85], v76
    ds_read_b64_tr_b16 a[86:87], v77
    v_add_u32 v76, s88, v76
    v_add_u32 v77, s88, v77
    s_waitcnt lgkmcnt(8)
    v_mfma_f32_16x16x32_bf16 v[80:83], v[16:19], a[68:71], v[80:83]
    ds_read_b64_tr_b16 a[88:89], v76
    ds_read_b64_tr_b16 a[90:91], v77
    v_add_u32 v76, s88, v76
    v_add_u32 v77, s88, v77
    s_waitcnt lgkmcnt(8)
    v_mfma_f32_16x16x32_bf16 v[80:83], v[16:19], a[72:75], v[80:83]
    ds_read_b64_tr_b16 a[92:93], v76
    ds_read_b64_tr_b16 a[94:95], v77
    s_waitcnt lgkmcnt(8)
    v_mfma_f32_16x16x32_bf16 v[80:83], v[16:19], a[76:79], v[80:83]
    s_waitcnt lgkmcnt(6)
    v_mfma_f32_16x16x32_bf16 v[80:83], v[16:19], a[80:83], v[80:83]
    s_waitcnt lgkmcnt(4)
    v_mfma_f32_16x16x32_bf16 v[80:83], v[16:19], a[84:87], v[80:83]
    s_waitcnt lgkmcnt(2)
    v_mfma_f32_16x16x32_bf16 v[80:83], v[16:19], a[88:91], v[80:83]
    s_waitcnt lgkmcnt(0)
    v_mfma_f32_16x16x32_bf16 v[80:83], v[16:19], a[92:95], v[80:83]
    s_lshl_b32 s89, s89, 6
    s_add_u32 s89, s89, 147456
    v_add_u32 v76, s89, v14
    s_nop 4
    ds_write_b32 v76, v80
    v_add_u32 v53, s82, v14
    ds_write_b32 v53, v54
    ds_write_b32 v53, v56 offset:64
    s_lshl_b32 s39, s62, 15
    s_add_u32 s39, s39, 81920
    v_add_u32 v58, s39, v35
    v_add_u32 v59, s39, v36
    v_add_u32 v60, s39, v37
    v_add_u32 v61, s39, v38
    s_lshl_b32 s39, s62, 14
    v_add_u32 v62, s39, v43
    v_add_u32 v63, s39, v44
    ds_read_b64_tr_b16 a[64:65], v58
    ds_read_b64_tr_b16 a[66:67], v58 offset:2048
    ds_read_b64_tr_b16 a[68:69], v59
    ds_read_b64_tr_b16 a[70:71], v59 offset:2048
    ds_read_b64_tr_b16 a[72:73], v60
    ds_read_b64_tr_b16 a[74:75], v60 offset:2048
    ds_read_b64_tr_b16 a[76:77], v61
    ds_read_b64_tr_b16 a[78:79], v61 offset:2048
    ds_read_b64_tr_b16 a[80:81], v58 offset:4096
    ds_read_b64_tr_b16 a[82:83], v58 offset:6144
    ds_read_b64_tr_b16 a[84:85], v59 offset:4096
    ds_read_b64_tr_b16 a[86:87], v59 offset:6144
    ds_read_b64_tr_b16 a[88:89], v60 offset:4096
    ds_read_b64_tr_b16 a[90:91], v60 offset:6144
    ds_read_b64_tr_b16 a[92:93], v61 offset:4096
    ds_read_b64_tr_b16 a[94:95], v61 offset:6144
    s_waitcnt lgkmcnt(8)
    v_mfma_f32_16x16x32_bf16 v[64:67], a[0:3], a[64:67], 0
    ds_read_b64_tr_b16 a[96:97], v58 offset:8192
    v_mfma_f32_16x16x32_bf16 v[80:83], a[32:35], a[64:67], 0
    ds_read_b64_tr_b16 a[98:99], v58 offset:10240
    v_mfma_f32_16x16x32_bf16 v[68:71], a[0:3], a[68:71], 0
    ds_read_b64_tr_b16 a[100:101], v59 offset:8192
    v_mfma_f32_16x16x32_bf16 v[84:87], a[32:35], a[68:71], 0
    ds_read_b64_tr_b16 a[102:103], v59 offset:10240
    v_mfma_f32_16x16x32_bf16 v[72:75], a[0:3], a[72:75], 0
    ds_read_b64_tr_b16 a[104:105], v60 offset:8192
    v_mfma_f32_16x16x32_bf16 v[88:91], a[32:35], a[72:75], 0
    ds_read_b64_tr_b16 a[106:107], v60 offset:10240
    v_mfma_f32_16x16x32_bf16 v[76:79], a[0:3], a[76:79], 0
    ds_read_b64_tr_b16 a[108:109], v61 offset:8192
    v_mfma_f32_16x16x32_bf16 v[92:95], a[32:35], a[76:79], 0
    ds_read_b64_tr_b16 a[110:111], v61 offset:10240
    s_waitcnt lgkmcnt(8)
    v_mfma_f32_16x16x32_bf16 v[64:67], a[4:7], a[80:83], v[64:67]
    ds_read_b64_tr_b16 a[64:65], v58 offset:12288
    v_mfma_f32_16x16x32_bf16 v[80:83], a[36:39], a[80:83], v[80:83]
    ds_read_b64_tr_b16 a[66:67], v58 offset:14336
    v_mfma_f32_16x16x32_bf16 v[68:71], a[4:7], a[84:87], v[68:71]
    ds_read_b64_tr_b16 a[68:69], v59 offset:12288
    v_mfma_f32_16x16x32_bf16 v[84:87], a[36:39], a[84:87], v[84:87]
    ds_read_b64_tr_b16 a[70:71], v59 offset:14336
    v_mfma_f32_16x16x32_bf16 v[72:75], a[4:7], a[88:91], v[72:75]
    ds_read_b64_tr_b16 a[72:73], v60 offset:12288
    v_mfma_f32_16x16x32_bf16 v[88:91], a[36:39], a[88:91], v[88:91]
    ds_read_b64_tr_b16 a[74:75], v60 offset:14336
    v_mfma_f32_16x16x32_bf16 v[76:79], a[4:7], a[92:95], v[76:79]
    ds_read_b64_tr_b16 a[76:77], v61 offset:12288
    v_mfma_f32_16x16x32_bf16 v[92:95], a[36:39], a[92:95], v[92:95]
    ds_read_b64_tr_b16 a[78:79], v61 offset:14336
    s_waitcnt lgkmcnt(8)
    v_mfma_f32_16x16x32_bf16 v[64:67], a[8:11], a[96:99], v[64:67]
    ds_read_b64_tr_b16 a[80:81], v58 offset:16384
    v_mfma_f32_16x16x32_bf16 v[80:83], a[40:43], a[96:99], v[80:83]
    ds_read_b64_tr_b16 a[82:83], v58 offset:18432
    v_mfma_f32_16x16x32_bf16 v[68:71], a[8:11], a[100:103], v[68:71]
    ds_read_b64_tr_b16 a[84:85], v59 offset:16384
    v_mfma_f32_16x16x32_bf16 v[84:87], a[40:43], a[100:103], v[84:87]
    ds_read_b64_tr_b16 a[86:87], v59 offset:18432
    v_mfma_f32_16x16x32_bf16 v[72:75], a[8:11], a[104:107], v[72:75]
    ds_read_b64_tr_b16 a[88:89], v60 offset:16384
    v_mfma_f32_16x16x32_bf16 v[88:91], a[40:43], a[104:107], v[88:91]
    ds_read_b64_tr_b16 a[90:91], v60 offset:18432
    v_mfma_f32_16x16x32_bf16 v[76:79], a[8:11], a[108:111], v[76:79]
    ds_read_b64_tr_b16 a[92:93], v61 offset:16384
    v_mfma_f32_16x16x32_bf16 v[92:95], a[40:43], a[108:111], v[92:95]
    ds_read_b64_tr_b16 a[94:95], v61 offset:18432
    s_waitcnt lgkmcnt(8)
    v_mfma_f32_16x16x32_bf16 v[64:67], a[12:15], a[64:67], v[64:67]
    ds_read_b64_tr_b16 a[96:97], v58 offset:20480
    v_mfma_f32_16x16x32_bf16 v[80:83], a[44:47], a[64:67], v[80:83]
    ds_read_b64_tr_b16 a[98:99], v58 offset:22528
    v_mfma_f32_16x16x32_bf16 v[68:71], a[12:15], a[68:71], v[68:71]
    ds_read_b64_tr_b16 a[100:101], v59 offset:20480
    v_mfma_f32_16x16x32_bf16 v[84:87], a[44:47], a[68:71], v[84:87]
    ds_read_b64_tr_b16 a[102:103], v59 offset:22528
    v_mfma_f32_16x16x32_bf16 v[72:75], a[12:15], a[72:75], v[72:75]
    ds_read_b64_tr_b16 a[104:105], v60 offset:20480
    v_mfma_f32_16x16x32_bf16 v[88:91], a[44:47], a[72:75], v[88:91]
    ds_read_b64_tr_b16 a[106:107], v60 offset:22528
    v_mfma_f32_16x16x32_bf16 v[76:79], a[12:15], a[76:79], v[76:79]
    ds_read_b64_tr_b16 a[108:109], v61 offset:20480
    v_mfma_f32_16x16x32_bf16 v[92:95], a[44:47], a[76:79], v[92:95]
    ds_read_b64_tr_b16 a[110:111], v61 offset:22528
    s_waitcnt lgkmcnt(8)
    v_mfma_f32_16x16x32_bf16 v[64:67], a[16:19], a[80:83], v[64:67]
    ds_read_b64_tr_b16 a[64:65], v58 offset:24576
    v_mfma_f32_16x16x32_bf16 v[80:83], a[48:51], a[80:83], v[80:83]
    ds_read_b64_tr_b16 a[66:67], v58 offset:26624
    v_mfma_f32_16x16x32_bf16 v[68:71], a[16:19], a[84:87], v[68:71]
    ds_read_b64_tr_b16 a[68:69], v59 offset:24576
    v_mfma_f32_16x16x32_bf16 v[84:87], a[48:51], a[84:87], v[84:87]
    ds_read_b64_tr_b16 a[70:71], v59 offset:26624
    v_mfma_f32_16x16x32_bf16 v[72:75], a[16:19], a[88:91], v[72:75]
    ds_read_b64_tr_b16 a[72:73], v60 offset:24576
    v_mfma_f32_16x16x32_bf16 v[88:91], a[48:51], a[88:91], v[88:91]
    ds_read_b64_tr_b16 a[74:75], v60 offset:26624
    v_mfma_f32_16x16x32_bf16 v[76:79], a[16:19], a[92:95], v[76:79]
    ds_read_b64_tr_b16 a[76:77], v61 offset:24576
    v_mfma_f32_16x16x32_bf16 v[92:95], a[48:51], a[92:95], v[92:95]
    ds_read_b64_tr_b16 a[78:79], v61 offset:26624
    s_waitcnt lgkmcnt(8)
    v_mfma_f32_16x16x32_bf16 v[64:67], a[20:23], a[96:99], v[64:67]
    ds_read_b64_tr_b16 a[80:81], v58 offset:28672
    v_mfma_f32_16x16x32_bf16 v[80:83], a[52:55], a[96:99], v[80:83]
    ds_read_b64_tr_b16 a[82:83], v58 offset:30720
    v_mfma_f32_16x16x32_bf16 v[68:71], a[20:23], a[100:103], v[68:71]
    ds_read_b64_tr_b16 a[84:85], v59 offset:28672
    v_mfma_f32_16x16x32_bf16 v[84:87], a[52:55], a[100:103], v[84:87]
    ds_read_b64_tr_b16 a[86:87], v59 offset:30720
    v_mfma_f32_16x16x32_bf16 v[72:75], a[20:23], a[104:107], v[72:75]
    ds_read_b64_tr_b16 a[88:89], v60 offset:28672
    v_mfma_f32_16x16x32_bf16 v[88:91], a[52:55], a[104:107], v[88:91]
    ds_read_b64_tr_b16 a[90:91], v60 offset:30720
    v_mfma_f32_16x16x32_bf16 v[76:79], a[20:23], a[108:111], v[76:79]
    ds_read_b64_tr_b16 a[92:93], v61 offset:28672
    v_mfma_f32_16x16x32_bf16 v[92:95], a[52:55], a[108:111], v[92:95]
    ds_read_b64_tr_b16 a[94:95], v61 offset:30720
    s_waitcnt lgkmcnt(8)
    v_mfma_f32_16x16x32_bf16 v[64:67], a[24:27], a[64:67], v[64:67]
    v_mfma_f32_16x16x32_bf16 v[80:83], a[56:59], a[64:67], v[80:83]
    v_mfma_f32_16x16x32_bf16 v[68:71], a[24:27], a[68:71], v[68:71]
    v_mfma_f32_16x16x32_bf16 v[84:87], a[56:59], a[68:71], v[84:87]
    v_mfma_f32_16x16x32_bf16 v[72:75], a[24:27], a[72:75], v[72:75]
    v_mfma_f32_16x16x32_bf16 v[88:91], a[56:59], a[72:75], v[88:91]
    v_mfma_f32_16x16x32_bf16 v[76:79], a[24:27], a[76:79], v[76:79]
    v_mfma_f32_16x16x32_bf16 v[92:95], a[56:59], a[76:79], v[92:95]
    s_waitcnt lgkmcnt(0)
    v_mfma_f32_16x16x32_bf16 v[64:67], a[28:31], a[80:83], v[64:67]
    v_mfma_f32_16x16x32_bf16 v[80:83], a[60:63], a[80:83], v[80:83]
    v_mfma_f32_16x16x32_bf16 v[68:71], a[28:31], a[84:87], v[68:71]
    v_mfma_f32_16x16x32_bf16 v[84:87], a[60:63], a[84:87], v[84:87]
    v_mfma_f32_16x16x32_bf16 v[72:75], a[28:31], a[88:91], v[72:75]
    v_mfma_f32_16x16x32_bf16 v[88:91], a[60:63], a[88:91], v[88:91]
    v_mfma_f32_16x16x32_bf16 v[76:79], a[28:31], a[92:95], v[76:79]
    v_mfma_f32_16x16x32_bf16 v[92:95], a[60:63], a[92:95], v[92:95]
    s_mul_i32 s39, s36, 4096
    s_add_u32 s39, s39, 32768
    v_add_u32 v96, s39, v4
    ds_write_b128 v96, v[80:83]
    ds_write_b128 v96, v[84:87] offset:1024
    s_nop 0
    ds_write_b128 v96, v[88:91] offset:2048
    s_nop 0
    ds_write_b128 v96, v[92:95] offset:3072
    s_xor_b32 s39, s36, 1
    s_mul_i32 s39, s39, 4096
    s_add_u32 s39, s39, 32768
    s_waitcnt lgkmcnt(0)
    s_barrier
    v_add_u32 v96, s39, v4
    ds_read_b128 v[80:83], v96
    ds_read_b128 v[84:87], v96 offset:1024
    ds_read_b128 v[88:91], v96 offset:2048
    ds_read_b128 v[92:95], v96 offset:3072
    v_add_u32 v53, s82, v15
    ds_read_b128 v[100:103], v53
    ds_read_b128 v[104:107], v53 offset:64
    v_add_u32 v53, 147456, v14
    ds_read_b32 v108, v53
    ds_read_b32 v110, v53 offset:64
    ds_read_b32 v112, v53 offset:128
    ds_read_b32 v114, v53 offset:192
    v_add_u32 v53, 147456, v15
    ds_read_b128 v[116:119], v53 offset:256
    ds_read_b128 v[120:123], v53 offset:320
    s_waitcnt lgkmcnt(11)
    v_pk_add_f32 v[64:65], v[64:65], v[80:81]
    v_pk_add_f32 v[66:67], v[66:67], v[82:83]
    s_waitcnt lgkmcnt(10)
    v_pk_add_f32 v[68:69], v[68:69], v[84:85]
    v_pk_add_f32 v[70:71], v[70:71], v[86:87]
    s_waitcnt lgkmcnt(9)
    v_pk_add_f32 v[72:73], v[72:73], v[88:89]
    v_pk_add_f32 v[74:75], v[74:75], v[90:91]
    s_waitcnt lgkmcnt(8)
    v_pk_add_f32 v[76:77], v[76:77], v[92:93]
    v_pk_add_f32 v[78:79], v[78:79], v[94:95]
    s_waitcnt lgkmcnt(0)
    v_pk_fma_f32 v[64:65], v[100:101], v[108:109], v[64:65] op_sel_hi:[1,0,1]
    v_pk_mul_f32 v[64:65], v[64:65], v[104:105]
    v_cvt_pk_bf16_f32 v7, v64, v65
    v_lshlrev_b32 v64, 16, v7
    v_and_b32 v65, 4294901760, v7
    v_min_f32 v26, 0, v64
    v_min_f32 v27, 0, v65
    v_pk_mul_f32 v[26:27], v[26:27], s[50:51]
    v_exp_f32 v26, v26
    v_exp_f32 v27, v27
    v_max_f32 v64, 0, v64
    v_max_f32 v65, 0, v65
    v_pk_add_f32 v[64:65], v[64:65], v[26:27]
    v_cvt_pk_bf16_f32 v7, v64, v65
    v_lshlrev_b32 v64, 16, v7
    v_and_b32 v65, 4294901760, v7
    v_pk_add_f32 v[64:65], v[64:65], s[54:55]
    v_cvt_pk_bf16_f32 v124, v64, v65
    v_pk_fma_f32 v[66:67], v[102:103], v[108:109], v[66:67] op_sel_hi:[1,0,1]
    v_pk_mul_f32 v[66:67], v[66:67], v[106:107]
    v_cvt_pk_bf16_f32 v7, v66, v67
    v_lshlrev_b32 v66, 16, v7
    v_and_b32 v67, 4294901760, v7
    v_min_f32 v26, 0, v66
    v_min_f32 v27, 0, v67
    v_pk_mul_f32 v[26:27], v[26:27], s[50:51]
    v_exp_f32 v26, v26
    v_exp_f32 v27, v27
    v_max_f32 v66, 0, v66
    v_max_f32 v67, 0, v67
    v_pk_add_f32 v[66:67], v[66:67], v[26:27]
    v_cvt_pk_bf16_f32 v7, v66, v67
    v_lshlrev_b32 v66, 16, v7
    v_and_b32 v67, 4294901760, v7
    v_pk_add_f32 v[66:67], v[66:67], s[54:55]
    v_cvt_pk_bf16_f32 v125, v66, v67
    v_pk_fma_f32 v[68:69], v[100:101], v[110:111], v[68:69] op_sel_hi:[1,0,1]
    v_pk_mul_f32 v[68:69], v[68:69], v[104:105]
    v_cvt_pk_bf16_f32 v7, v68, v69
    v_lshlrev_b32 v68, 16, v7
    v_and_b32 v69, 4294901760, v7
    v_min_f32 v26, 0, v68
    v_min_f32 v27, 0, v69
    v_pk_mul_f32 v[26:27], v[26:27], s[50:51]
    v_exp_f32 v26, v26
    v_exp_f32 v27, v27
    v_max_f32 v68, 0, v68
    v_max_f32 v69, 0, v69
    v_pk_add_f32 v[68:69], v[68:69], v[26:27]
    v_cvt_pk_bf16_f32 v7, v68, v69
    v_lshlrev_b32 v68, 16, v7
    v_and_b32 v69, 4294901760, v7
    v_pk_add_f32 v[68:69], v[68:69], s[54:55]
    v_cvt_pk_bf16_f32 v126, v68, v69
    v_pk_fma_f32 v[70:71], v[102:103], v[110:111], v[70:71] op_sel_hi:[1,0,1]
    v_pk_mul_f32 v[70:71], v[70:71], v[106:107]
    v_cvt_pk_bf16_f32 v7, v70, v71
    v_lshlrev_b32 v70, 16, v7
    v_and_b32 v71, 4294901760, v7
    v_min_f32 v26, 0, v70
    v_min_f32 v27, 0, v71
    v_pk_mul_f32 v[26:27], v[26:27], s[50:51]
    v_exp_f32 v26, v26
    v_exp_f32 v27, v27
    v_max_f32 v70, 0, v70
    v_max_f32 v71, 0, v71
    v_pk_add_f32 v[70:71], v[70:71], v[26:27]
    v_cvt_pk_bf16_f32 v7, v70, v71
    v_lshlrev_b32 v70, 16, v7
    v_and_b32 v71, 4294901760, v7
    v_pk_add_f32 v[70:71], v[70:71], s[54:55]
    v_cvt_pk_bf16_f32 v127, v70, v71
    v_pk_fma_f32 v[72:73], v[100:101], v[112:113], v[72:73] op_sel_hi:[1,0,1]
    v_pk_mul_f32 v[72:73], v[72:73], v[104:105]
    v_cvt_pk_bf16_f32 v128, v72, v73
    v_pk_fma_f32 v[74:75], v[102:103], v[112:113], v[74:75] op_sel_hi:[1,0,1]
    v_pk_mul_f32 v[74:75], v[74:75], v[106:107]
    v_cvt_pk_bf16_f32 v129, v74, v75
    v_pk_fma_f32 v[76:77], v[100:101], v[114:115], v[76:77] op_sel_hi:[1,0,1]
    v_pk_mul_f32 v[76:77], v[76:77], v[104:105]
    v_cvt_pk_bf16_f32 v130, v76, v77
    v_pk_fma_f32 v[78:79], v[102:103], v[114:115], v[78:79] op_sel_hi:[1,0,1]
    v_pk_mul_f32 v[78:79], v[78:79], v[106:107]
    v_cvt_pk_bf16_f32 v131, v78, v79
    v_mfma_f32_16x16x16_bf16 v[64:67], v[128:129], v[124:125], 0
    v_mfma_f32_16x16x16_bf16 v[72:75], v[16:17], v[124:125], 0
    v_mfma_f32_16x16x16_bf16 v[68:71], v[130:131], v[126:127], 0
    v_mfma_f32_16x16x16_bf16 v[76:79], v[16:17], v[126:127], 0
    s_mul_i32 s39, s36, 2560
    s_add_u32 s39, s39, 126976
    v_add_u32 v58, s39, v4
    v_lshlrev_b32 v59, 2, v1
    v_add_u32 v59, s39, v59
    ds_write_b128 v58, v[64:67]
    ds_write_b32 v59, v72 offset:2048
    ds_write_b128 v58, v[68:71] offset:1024
    ds_write_b32 v59, v76 offset:2304
    s_mov_b32 s60, 0
    s_cmp_lg_u32 s36, 0
    s_nop 3
    s_cbranch_scc1 Linterleave_layers__linear_attn_block__dense_activation_silu__prompt_kernel_6
Linterleave_layers__linear_attn_block__dense_activation_silu__prompt_kernel_5:
    buffer_load_dword v13, v14, s[28:31], 0 offen sc1
    s_waitcnt vmcnt(0)
    v_cmp_eq_u32 vcc, 0, v13
    s_nop 4
    s_cmp_eq_u64 vcc, 0
    s_cbranch_scc1 Linterleave_layers__linear_attn_block__dense_activation_silu__prompt_kernel_6
    s_sleep 2
    s_add_u32 s60, s60, 1
    s_cmp_lt_u32 s60, 0x40000
    s_cbranch_scc1 Linterleave_layers__linear_attn_block__dense_activation_silu__prompt_kernel_5
Linterleave_layers__linear_attn_block__dense_activation_silu__prompt_kernel_6:
    s_nop 3
    s_waitcnt lgkmcnt(0)
    s_barrier
    s_and_b32 s39, s36, 1
    s_lshr_b32 s40, s36, 1
    s_lshl_b32 s88, s39, 10
    s_lshl_b32 s89, s40, 6
    s_add_u32 s88, s88, s89
    s_add_u32 s88, s88, 126976
    s_lshl_b32 s89, s39, 8
    s_add_u32 s89, s89, 129024
    v_lshlrev_b32 v58, 8, v3
    v_and_b32 v5, 3, v1
    v_lshl_add_u32 v58, v5, 4, v58
    v_bfe_u32 v5, v1, 2, 2
    v_lshl_add_u32 v58, v5, 2, v58
    v_add_u32 v58, s88, v58
    v_lshlrev_b32 v59, 2, v1
    v_add_u32 v59, s89, v59
    ds_read_b32 v80, v58
    ds_read_b32 v88, v59
    ds_read_b32 v81, v58 offset:2560
    ds_read_b32 v89, v59 offset:2560
    ds_read_b32 v82, v58 offset:5120
    ds_read_b32 v90, v59 offset:5120
    ds_read_b32 v83, v58 offset:7680
    ds_read_b32 v91, v59 offset:7680
    ds_read_b32 v84, v58 offset:10240
    ds_read_b32 v92, v59 offset:10240
    ds_read_b32 v85, v58 offset:12800
    ds_read_b32 v93, v59 offset:12800
    ds_read_b32 v86, v58 offset:15360
    ds_read_b32 v94, v59 offset:15360
    ds_read_b32 v87, v58 offset:17920
    ds_read_b32 v95, v59 offset:17920
    s_lshl_b32 s90, s43, 1
    s_add_u32 s90, s90, s39
    s_lshl_b32 s91, s90, 6
    s_add_u32 s91, s91, 0x1a08000
    s_lshl_b32 s90, s90, 10
    s_lshl_b32 s39, s40, 8
    s_add_u32 s90, s90, s39
    s_add_u32 s90, s90, 0x1a00000
    s_cmp_eq_u32 s40, 0
    s_cselect_b32 s91, s91, 0x7ff00000
    v_lshlrev_b32 v60, 2, v1
    v_mov_b32 v5, 0x7ff00000
    v_cmp_gt_u32 vcc, 16, v1
    s_nop 1
    v_cndmask_b32 v61, v5, v60, vcc
    s_waitcnt lgkmcnt(0)
    v_add_f32 v80, v80, v81
    v_add_f32 v82, v82, v83
    v_add_f32 v84, v84, v85
    v_add_f32 v86, v86, v87
    v_add_f32 v80, v80, v82
    v_add_f32 v84, v84, v86
    v_add_f32 v80, v80, v84
    v_add_f32 v88, v88, v89
    v_add_f32 v90, v90, v91
    v_add_f32 v92, v92, v93
    v_add_f32 v94, v94, v95
    v_add_f32 v88, v88, v90
    v_add_f32 v92, v92, v94
    v_add_f32 v88, v88, v92
    buffer_atomic_add_f32 v80, v60, s[32:35], s90 offen
    buffer_atomic_add_f32 v88, v61, s[32:35], s91 offen
    ds_read_b64_tr_b16 a[64:65], v62
    ds_read_b64_tr_b16 a[66:67], v62 offset:1024
    ds_read_b64_tr_b16 a[68:69], v63
    ds_read_b64_tr_b16 a[70:71], v63 offset:1024
    ds_read_b64_tr_b16 a[80:81], v62 offset:2048
    ds_read_b64_tr_b16 a[82:83], v62 offset:3072
    ds_read_b64_tr_b16 a[84:85], v63 offset:2048
    ds_read_b64_tr_b16 a[86:87], v63 offset:3072
    s_waitcnt lgkmcnt(4)
    v_mfma_f32_16x16x32_bf16 v[64:67], a[64:67], a[0:3], 0
    ds_read_b64_tr_b16 a[96:97], v62 offset:4096
    v_mfma_f32_16x16x32_bf16 v[72:75], a[64:67], a[32:35], 0
    ds_read_b64_tr_b16 a[98:99], v62 offset:5120
    v_mfma_f32_16x16x32_bf16 v[68:71], a[68:71], a[0:3], 0
    ds_read_b64_tr_b16 a[100:101], v63 offset:4096
    v_mfma_f32_16x16x32_bf16 v[76:79], a[68:71], a[32:35], 0
    ds_read_b64_tr_b16 a[102:103], v63 offset:5120
    s_waitcnt lgkmcnt(4)
    v_mfma_f32_16x16x32_bf16 v[64:67], a[80:83], a[4:7], v[64:67]
    ds_read_b64_tr_b16 a[64:65], v62 offset:6144
    v_mfma_f32_16x16x32_bf16 v[72:75], a[80:83], a[36:39], v[72:75]
    ds_read_b64_tr_b16 a[66:67], v62 offset:7168
    v_mfma_f32_16x16x32_bf16 v[68:71], a[84:87], a[4:7], v[68:71]
    ds_read_b64_tr_b16 a[68:69], v63 offset:6144
    v_mfma_f32_16x16x32_bf16 v[76:79], a[84:87], a[36:39], v[76:79]
    ds_read_b64_tr_b16 a[70:71], v63 offset:7168
    s_waitcnt lgkmcnt(4)
    v_mfma_f32_16x16x32_bf16 v[64:67], a[96:99], a[8:11], v[64:67]
    ds_read_b64_tr_b16 a[80:81], v62 offset:8192
    v_mfma_f32_16x16x32_bf16 v[72:75], a[96:99], a[40:43], v[72:75]
    ds_read_b64_tr_b16 a[82:83], v62 offset:9216
    v_mfma_f32_16x16x32_bf16 v[68:71], a[100:103], a[8:11], v[68:71]
    ds_read_b64_tr_b16 a[84:85], v63 offset:8192
    v_mfma_f32_16x16x32_bf16 v[76:79], a[100:103], a[40:43], v[76:79]
    ds_read_b64_tr_b16 a[86:87], v63 offset:9216
    s_waitcnt lgkmcnt(4)
    v_mfma_f32_16x16x32_bf16 v[64:67], a[64:67], a[12:15], v[64:67]
    ds_read_b64_tr_b16 a[96:97], v62 offset:10240
    v_mfma_f32_16x16x32_bf16 v[72:75], a[64:67], a[44:47], v[72:75]
    ds_read_b64_tr_b16 a[98:99], v62 offset:11264
    v_mfma_f32_16x16x32_bf16 v[68:71], a[68:71], a[12:15], v[68:71]
    ds_read_b64_tr_b16 a[100:101], v63 offset:10240
    v_mfma_f32_16x16x32_bf16 v[76:79], a[68:71], a[44:47], v[76:79]
    ds_read_b64_tr_b16 a[102:103], v63 offset:11264
    s_waitcnt lgkmcnt(4)
    v_mfma_f32_16x16x32_bf16 v[64:67], a[80:83], a[16:19], v[64:67]
    ds_read_b64_tr_b16 a[64:65], v62 offset:12288
    v_mfma_f32_16x16x32_bf16 v[72:75], a[80:83], a[48:51], v[72:75]
    ds_read_b64_tr_b16 a[66:67], v62 offset:13312
    v_mfma_f32_16x16x32_bf16 v[68:71], a[84:87], a[16:19], v[68:71]
    ds_read_b64_tr_b16 a[68:69], v63 offset:12288
    v_mfma_f32_16x16x32_bf16 v[76:79], a[84:87], a[48:51], v[76:79]
    ds_read_b64_tr_b16 a[70:71], v63 offset:13312
    s_waitcnt lgkmcnt(4)
    v_mfma_f32_16x16x32_bf16 v[64:67], a[96:99], a[20:23], v[64:67]
    ds_read_b64_tr_b16 a[80:81], v62 offset:14336
    v_mfma_f32_16x16x32_bf16 v[72:75], a[96:99], a[52:55], v[72:75]
    ds_read_b64_tr_b16 a[82:83], v62 offset:15360
    v_mfma_f32_16x16x32_bf16 v[68:71], a[100:103], a[20:23], v[68:71]
    ds_read_b64_tr_b16 a[84:85], v63 offset:14336
    v_mfma_f32_16x16x32_bf16 v[76:79], a[100:103], a[52:55], v[76:79]
    ds_read_b64_tr_b16 a[86:87], v63 offset:15360
    s_waitcnt lgkmcnt(4)
    v_mfma_f32_16x16x32_bf16 v[64:67], a[64:67], a[24:27], v[64:67]
    v_mfma_f32_16x16x32_bf16 v[72:75], a[64:67], a[56:59], v[72:75]
    v_mfma_f32_16x16x32_bf16 v[68:71], a[68:71], a[24:27], v[68:71]
    v_mfma_f32_16x16x32_bf16 v[76:79], a[68:71], a[56:59], v[76:79]
    s_waitcnt lgkmcnt(0)
    v_mfma_f32_16x16x32_bf16 v[64:67], a[80:83], a[28:31], v[64:67]
    v_mfma_f32_16x16x32_bf16 v[72:75], a[80:83], a[60:63], v[72:75]
    v_mfma_f32_16x16x32_bf16 v[68:71], a[84:87], a[28:31], v[68:71]
    v_mfma_f32_16x16x32_bf16 v[76:79], a[84:87], a[60:63], v[76:79]
    s_waitcnt vmcnt(0)
    s_mul_i32 s39, s36, 4096
    s_add_u32 s39, s39, 32768
    v_add_u32 v132, s39, v4
    s_nop 1
    ds_write_b128 v132, v[72:75]
    s_nop 0
    ds_write_b128 v132, v[76:79] offset:1024
    s_xor_b32 s39, s36, 1
    s_mul_i32 s39, s39, 4096
    s_add_u32 s39, s39, 32768
    s_waitcnt lgkmcnt(0)
    s_barrier
    v_add_u32 v132, s39, v4
    ds_read_b128 v[72:75], v132
    ds_read_b128 v[76:79], v132 offset:1024
    s_cmp_lg_u32 s36, 0
    s_nop 3
    s_cbranch_scc1 Linterleave_layers__linear_attn_block__dense_activation_silu__prompt_kernel_7
    v_mov_b32 v13, 1
    buffer_atomic_add v13, v11, s[32:35], s44 offen offset:192 sc0 sc1
    s_waitcnt vmcnt(0)
    v_readfirstlane_b32 s39, v13
    s_nop 4
    s_cmp_lg_u32 s39, 15
    s_cbranch_scc1 Linterleave_layers__linear_attn_block__dense_activation_silu__prompt_kernel_7
    v_mov_b32 v13, 1
    buffer_store_dword v13, v12, s[32:35], s45 offen sc1
Linterleave_layers__linear_attn_block__dense_activation_silu__prompt_kernel_7:
    s_nop 3
    s_waitcnt lgkmcnt(1)
    v_pk_add_f32 v[64:65], v[64:65], v[72:73]
    v_pk_add_f32 v[66:67], v[66:67], v[74:75]
    s_waitcnt lgkmcnt(0)
    v_pk_add_f32 v[68:69], v[68:69], v[76:77]
    v_pk_add_f32 v[70:71], v[70:71], v[78:79]
    v_pk_fma_f32 v[64:65], v[116:117], v[54:55], v[64:65] op_sel_hi:[1,0,1]
    v_pk_mul_f32 v[64:65], v[64:65], v[56:57] op_sel_hi:[1,0]
    v_cvt_pk_bf16_f32 v7, v64, v65
    v_lshlrev_b32 v64, 16, v7
    v_and_b32 v65, 4294901760, v7
    v_min_f32 v26, 0, v64
    v_min_f32 v27, 0, v65
    v_pk_mul_f32 v[26:27], v[26:27], s[50:51]
    s_add_u32 m0, s58, 81920
    s_add_u32 s73, s76, 0
    buffer_load_dwordx4 v30, s[12:15], s73 offen lds
    v_exp_f32 v26, v26
    v_exp_f32 v27, v27
    v_max_f32 v64, 0, v64
    v_max_f32 v65, 0, v65
    v_pk_add_f32 v[64:65], v[64:65], v[26:27]
    v_cvt_pk_bf16_f32 v7, v64, v65
    v_lshlrev_b32 v64, 16, v7
    v_and_b32 v65, 4294901760, v7
    v_pk_add_f32 v[64:65], v[64:65], s[54:55]
    v_cvt_pk_bf16_f32 v100, v64, v65
    v_pk_fma_f32 v[66:67], v[118:119], v[54:55], v[66:67] op_sel_hi:[1,0,1]
    v_pk_mul_f32 v[66:67], v[66:67], v[56:57] op_sel_hi:[1,0]
    s_add_u32 m0, s58, 90112
    s_add_u32 s73, s76, 65536
    buffer_load_dwordx4 v30, s[12:15], s73 offen lds
    v_cvt_pk_bf16_f32 v7, v66, v67
    v_lshlrev_b32 v66, 16, v7
    v_and_b32 v67, 4294901760, v7
    v_min_f32 v26, 0, v66
    v_min_f32 v27, 0, v67
    v_pk_mul_f32 v[26:27], v[26:27], s[50:51]
    v_exp_f32 v26, v26
    v_exp_f32 v27, v27
    v_max_f32 v66, 0, v66
    v_max_f32 v67, 0, v67
    v_pk_add_f32 v[66:67], v[66:67], v[26:27]
    v_cvt_pk_bf16_f32 v7, v66, v67
    s_add_u32 m0, s58, 98304
    s_add_u32 s73, s76, 131072
    buffer_load_dwordx4 v30, s[12:15], s73 offen lds
    v_lshlrev_b32 v66, 16, v7
    v_and_b32 v67, 4294901760, v7
    v_pk_add_f32 v[66:67], v[66:67], s[54:55]
    v_cvt_pk_bf16_f32 v101, v66, v67
    v_pk_fma_f32 v[68:69], v[120:121], v[54:55], v[68:69] op_sel_hi:[1,0,1]
    v_pk_mul_f32 v[68:69], v[68:69], v[56:57] op_sel_hi:[1,0]
    v_cvt_pk_bf16_f32 v7, v68, v69
    v_lshlrev_b32 v68, 16, v7
    v_and_b32 v69, 4294901760, v7
    v_min_f32 v26, 0, v68
    v_min_f32 v27, 0, v69
    v_pk_mul_f32 v[26:27], v[26:27], s[50:51]
    s_add_u32 m0, s58, 106496
    s_add_u32 s73, s76, 196608
    buffer_load_dwordx4 v30, s[12:15], s73 offen lds
    v_exp_f32 v26, v26
    v_exp_f32 v27, v27
    v_max_f32 v68, 0, v68
    v_max_f32 v69, 0, v69
    v_pk_add_f32 v[68:69], v[68:69], v[26:27]
    v_cvt_pk_bf16_f32 v7, v68, v69
    v_lshlrev_b32 v68, 16, v7
    v_and_b32 v69, 4294901760, v7
    v_pk_add_f32 v[68:69], v[68:69], s[54:55]
    v_cvt_pk_bf16_f32 v102, v68, v69
    v_pk_fma_f32 v[70:71], v[122:123], v[54:55], v[70:71] op_sel_hi:[1,0,1]
    v_pk_mul_f32 v[70:71], v[70:71], v[56:57] op_sel_hi:[1,0]
    s_add_u32 m0, s58, 114688
    s_add_u32 s73, s76, 262144
    buffer_load_dwordx4 v30, s[12:15], s73 offen lds
    v_cvt_pk_bf16_f32 v7, v70, v71
    v_lshlrev_b32 v70, 16, v7
    v_and_b32 v71, 4294901760, v7
    v_min_f32 v26, 0, v70
    v_min_f32 v27, 0, v71
    v_pk_mul_f32 v[26:27], v[26:27], s[50:51]
    v_exp_f32 v26, v26
    v_exp_f32 v27, v27
    v_max_f32 v70, 0, v70
    v_max_f32 v71, 0, v71
    v_pk_add_f32 v[70:71], v[70:71], v[26:27]
    v_cvt_pk_bf16_f32 v7, v70, v71
    s_add_u32 m0, s58, 122880
    s_add_u32 s73, s76, 327680
    buffer_load_dwordx4 v30, s[12:15], s73 offen lds
    v_lshlrev_b32 v70, 16, v7
    v_and_b32 v71, 4294901760, v7
    v_pk_add_f32 v[70:71], v[70:71], s[54:55]
    v_cvt_pk_bf16_f32 v103, v70, v71
    s_lshl_b32 s92, s61, 4
    s_add_u32 s92, s92, s43
    s_lshl_b32 s92, s92, 10
    buffer_store_dwordx4 v[100:103], v4, s[32:35], s92 offen sc1
    s_lshl_b32 s82, s36, 12
    s_add_u32 s82, s82, 0x1a00000
    s_lshl_b32 s83, s36, 8
    s_add_u32 s83, s83, 0x1a08000
    v_lshlrev_b32 v76, 4, v2
    s_lshl_b32 s84, s63, 4
    s_lshl_b32 s39, s62, 3
    s_add_u32 s84, s84, s39
    s_lshl_b32 s84, s84, 10
    s_add_u32 s85, s84, 4096
    s_waitcnt vmcnt(0)
    s_barrier
    buffer_atomic_add v9, v11, s[32:35], s44 offen sc1
    s_add_u32 m0, s58, 131072
    s_add_u32 s73, s76, 393216
    buffer_load_dwordx4 v30, s[12:15], s73 offen lds
    s_add_u32 m0, s58, 139264
    s_add_u32 s73, s76, 458752
    buffer_load_dwordx4 v30, s[12:15], s73 offen lds
    s_mov_b32 s60, 0
    s_cmp_lg_u32 s36, 0
    s_nop 3
    s_cbranch_scc1 Linterleave_layers__linear_attn_block__dense_activation_silu__prompt_kernel_9
Linterleave_layers__linear_attn_block__dense_activation_silu__prompt_kernel_8:
    buffer_load_dword v13, v14, s[32:35], s44 offen offset:128 sc1
    s_waitcnt vmcnt(0)
    v_cmp_gt_u32 vcc, 1, v13
    s_nop 4
    s_cmp_eq_u64 vcc, 0
    s_cbranch_scc1 Linterleave_layers__linear_attn_block__dense_activation_silu__prompt_kernel_9
    s_sleep 2
    s_add_u32 s60, s60, 1
    s_cmp_lt_u32 s60, 0x40000
    s_cbranch_scc1 Linterleave_layers__linear_attn_block__dense_activation_silu__prompt_kernel_8
Linterleave_layers__linear_attn_block__dense_activation_silu__prompt_kernel_9:
    s_nop 3
    s_mov_b32 s60, 0
    s_cmp_lg_u32 s36, 0
    s_nop 3
    s_cbranch_scc1 Linterleave_layers__linear_attn_block__dense_activation_silu__prompt_kernel_11
Linterleave_layers__linear_attn_block__dense_activation_silu__prompt_kernel_10:
    buffer_load_dword v13, v10, s[32:35], s44 offen sc1
    s_waitcnt vmcnt(0)
    v_readfirstlane_b32 s39, v13
    s_nop 4
    s_cmp_ge_u32 s39, 16
    s_cbranch_scc1 Linterleave_layers__linear_attn_block__dense_activation_silu__prompt_kernel_11
    s_sleep 2
    s_add_u32 s60, s60, 1
    s_cmp_lt_u32 s60, 0x40000
    s_cbranch_scc1 Linterleave_layers__linear_attn_block__dense_activation_silu__prompt_kernel_10
Linterleave_layers__linear_attn_block__dense_activation_silu__prompt_kernel_11:
    s_nop 3
    s_waitcnt vmcnt(0)
    s_barrier
    buffer_load_dwordx4 v[56:59], v4, s[32:35], s82 offen sc1
    buffer_load_dwordx4 v[60:63], v4, s[32:35], s82 offen offset:1024 sc1
    buffer_load_dwordx4 v[64:67], v4, s[32:35], s82 offen offset:2048 sc1
    buffer_load_dwordx4 v[68:71], v4, s[32:35], s82 offen offset:3072 sc1
    buffer_load_dwordx4 v[72:75], v76, s[32:35], s83 offen sc1
    buffer_load_dwordx4 a[0:3], v4, s[32:35], s84 offen sc1
    buffer_load_dwordx4 a[4:7], v4, s[32:35], s84 offen offset:1024 sc1
    buffer_load_dwordx4 a[8:11], v4, s[32:35], s84 offen offset:2048 sc1
    buffer_load_dwordx4 a[12:15], v4, s[32:35], s84 offen offset:3072 sc1
    buffer_load_dwordx4 a[16:19], v4, s[32:35], s85 offen sc1
    buffer_load_dwordx4 a[20:23], v4, s[32:35], s85 offen offset:1024 sc1
    buffer_load_dwordx4 a[24:27], v4, s[32:35], s85 offen offset:2048 sc1
    buffer_load_dwordx4 a[28:31], v4, s[32:35], s85 offen offset:3072 sc1
    v_lshlrev_b32 v84, 10, v2
    v_lshl_add_u32 v84, v3, 3, v84
    s_lshl_b32 s86, s63, 14
    s_lshl_b32 s39, s65, 6
    s_add_u32 s86, s86, s39
    buffer_load_dwordx2 v[80:81], v84, s[4:7], s86 offen
    buffer_load_dwordx2 v[82:83], v84, s[4:7], s86 offen offset:32
    v_lshlrev_b32 v85, 3, v1
    s_lshl_b32 s39, s36, 11
    s_add_u32 s39, s39, 65536
    v_add_u32 v85, s39, v85
    s_lshl_b32 s39, s36, 8
    s_add_u32 s39, s39, 149504
    v_add_u32 v86, s39, v76
    v_bfe_u32 v5, v1, 2, 1
    v_cmp_eq_u32 s[88:89], 1, v5
    s_waitcnt vmcnt(10)
    v_cvt_pk_bf16_f32 v56, v56, v57
    v_cvt_pk_bf16_f32 v57, v58, v59
    ds_write_b64 v85, v[56:57]
    v_cvt_pk_bf16_f32 v60, v60, v61
    v_cvt_pk_bf16_f32 v61, v62, v63
    ds_write_b64 v85, v[60:61] offset:512
    v_cvt_pk_bf16_f32 v64, v64, v65
    v_cvt_pk_bf16_f32 v65, v66, v67
    ds_write_b64 v85, v[64:65] offset:1024
    v_cvt_pk_bf16_f32 v68, v68, v69
    v_cvt_pk_bf16_f32 v69, v70, v71
    ds_write_b64 v85, v[68:69] offset:1536
    v_cvt_pk_bf16_f32 v5, v72, v73
    v_cvt_pk_bf16_f32 v6, v74, v75
    v_cndmask_b32 v72, v5, v10, s[88:89]
    v_cndmask_b32 v73, v6, v10, s[88:89]
    v_cndmask_b32 v74, v10, v5, s[88:89]
    v_cndmask_b32 v75, v10, v6, s[88:89]
    ds_write_b128 v86, v[72:75]
    s_waitcnt lgkmcnt(0)
    s_barrier
    v_lshlrev_b32 v85, 3, v1
    s_lshl_b32 s39, s62, 13
    s_add_u32 s39, s39, 65536
    v_add_u32 v85, s39, v85
    v_and_b32 v5, 1, v1
    v_lshlrev_b32 v87, 6, v5
    v_lshl_add_u32 v87, v3, 4, v87
    s_lshl_b32 s39, s62, 10
    s_add_u32 s39, s39, 149504
    v_add_u32 v87, s39, v87
    ds_read_b64 a[32:33], v85
    ds_read_b64 a[34:35], v85 offset:512
    ds_read_b128 a[64:67], v87
    ds_read_b64 a[36:37], v85 offset:1024
    ds_read_b64 a[38:39], v85 offset:1536
    ds_read_b128 a[68:71], v87 offset:128
    ds_read_b64 a[40:41], v85 offset:2048
    ds_read_b64 a[42:43], v85 offset:2560
    ds_read_b128 a[72:75], v87 offset:256
    ds_read_b64 a[44:45], v85 offset:3072
    ds_read_b64 a[46:47], v85 offset:3584
    ds_read_b128 a[76:79], v87 offset:384
    ds_read_b64 a[48:49], v85 offset:4096
    ds_read_b64 a[50:51], v85 offset:4608
    ds_read_b128 a[80:83], v87 offset:512
    ds_read_b64 a[52:53], v85 offset:5120
    ds_read_b64 a[54:55], v85 offset:5632
    ds_read_b128 a[84:87], v87 offset:640
    ds_read_b64 a[56:57], v85 offset:6144
    ds_read_b64 a[58:59], v85 offset:6656
    ds_read_b128 a[88:91], v87 offset:768
    ds_read_b64 a[60:61], v85 offset:7168
    ds_read_b64 a[62:63], v85 offset:7680
    ds_read_b128 a[92:95], v87 offset:896
    s_lshl_b32 s39, s62, 15
    s_add_u32 s39, s39, 81920
    v_add_u32 v120, s39, v39
    v_add_u32 v121, s39, v40
    v_add_u32 v122, s39, v41
    v_add_u32 v123, s39, v42
    s_waitcnt lgkmcnt(15)
    s_waitcnt vmcnt(9)
    v_mfma_f32_16x16x32_bf16 v[112:115], a[64:67], a[0:3], 0
    v_mfma_f32_16x16x16_bf16 v[96:99], a[32:33], a[0:1], 0
    v_mfma_f32_16x16x16_bf16 v[100:103], a[34:35], a[2:3], 0
    s_waitcnt vmcnt(8)
    v_mfma_f32_16x16x32_bf16 v[116:119], a[68:71], a[4:7], 0
    v_mfma_f32_16x16x16_bf16 v[104:107], a[36:37], a[4:5], 0
    s_add_u32 m0, s58, 0
    s_add_u32 s73, s77, 0
    buffer_load_dwordx4 v29, s[16:19], s73 offen lds
    v_mfma_f32_16x16x16_bf16 v[108:111], a[38:39], a[6:7], 0
    ds_read_b64_tr_b16 a[96:97], v120
    ds_read_b64_tr_b16 a[98:99], v120 offset:2048
    ds_read_b64_tr_b16 a[100:101], v121
    ds_read_b64_tr_b16 a[102:103], v121 offset:2048
    ds_read_b64_tr_b16 a[104:105], v122
    ds_read_b64_tr_b16 a[106:107], v122 offset:2048
    ds_read_b64_tr_b16 a[108:109], v123
    ds_read_b64_tr_b16 a[110:111], v123 offset:2048
    v_cvt_pk_bf16_f32 v7, v112, v113
    v_lshlrev_b32 v112, 16, v7
    v_and_b32 v113, 4294901760, v7
    v_pk_add_f32 v[112:113], v[112:113], s[54:55]
    v_cvt_pk_bf16_f32 v7, v112, v113
    v_lshlrev_b32 v112, 16, v7
    v_and_b32 v113, 4294901760, v7
    v_rcp_f32 v114, v113
    v_rcp_f32 v112, v112
    s_nop 0
    v_pk_mul_f32 v[96:97], v[96:97], v[112:113] op_sel_hi:[1,0]
    v_pk_mul_f32 v[98:99], v[98:99], v[112:113] op_sel_hi:[1,0]
    v_cvt_pk_bf16_f32 v88, v96, v97
    v_cvt_pk_bf16_f32 v89, v98, v99
    v_pk_mul_f32 v[100:101], v[100:101], v[114:115] op_sel_hi:[1,0]
    v_pk_mul_f32 v[102:103], v[102:103], v[114:115] op_sel_hi:[1,0]
    v_cvt_pk_bf16_f32 v90, v100, v101
    v_cvt_pk_bf16_f32 v91, v102, v103
    s_waitcnt lgkmcnt(0)
    s_nop 0
    v_mfma_f32_16x16x32_bf16 v[56:59], a[96:99], v[88:91], 0
    s_add_u32 m0, s58, 8192
    s_add_u32 s73, s77, 229376
    buffer_load_dwordx4 v29, s[16:19], s73 offen lds
    v_mfma_f32_16x16x32_bf16 v[60:63], a[100:103], v[88:91], 0
    v_mfma_f32_16x16x32_bf16 v[64:67], a[104:107], v[88:91], 0
    v_mfma_f32_16x16x32_bf16 v[68:71], a[108:111], v[88:91], 0
    s_waitcnt vmcnt(9)
    v_mfma_f32_16x16x32_bf16 v[112:115], a[72:75], a[8:11], 0
    v_mfma_f32_16x16x16_bf16 v[96:99], a[40:41], a[8:9], 0
    v_mfma_f32_16x16x16_bf16 v[100:103], a[42:43], a[10:11], 0
    s_add_u32 m0, s58, 16384
    s_add_u32 s73, s77, 458752
    buffer_load_dwordx4 v29, s[16:19], s73 offen lds
    ds_read_b64_tr_b16 a[96:97], v120 offset:4096
    ds_read_b64_tr_b16 a[98:99], v120 offset:6144
    ds_read_b64_tr_b16 a[100:101], v121 offset:4096
    ds_read_b64_tr_b16 a[102:103], v121 offset:6144
    ds_read_b64_tr_b16 a[104:105], v122 offset:4096
    ds_read_b64_tr_b16 a[106:107], v122 offset:6144
    ds_read_b64_tr_b16 a[108:109], v123 offset:4096
    ds_read_b64_tr_b16 a[110:111], v123 offset:6144
    v_cvt_pk_bf16_f32 v7, v116, v117
    v_lshlrev_b32 v116, 16, v7
    v_and_b32 v117, 4294901760, v7
    v_pk_add_f32 v[116:117], v[116:117], s[54:55]
    v_cvt_pk_bf16_f32 v7, v116, v117
    v_lshlrev_b32 v116, 16, v7
    v_and_b32 v117, 4294901760, v7
    v_rcp_f32 v118, v117
    v_rcp_f32 v116, v116
    s_nop 0
    v_pk_mul_f32 v[104:105], v[104:105], v[116:117] op_sel_hi:[1,0]
    v_pk_mul_f32 v[106:107], v[106:107], v[116:117] op_sel_hi:[1,0]
    v_cvt_pk_bf16_f32 v92, v104, v105
    v_cvt_pk_bf16_f32 v93, v106, v107
    v_pk_mul_f32 v[108:109], v[108:109], v[118:119] op_sel_hi:[1,0]
    v_pk_mul_f32 v[110:111], v[110:111], v[118:119] op_sel_hi:[1,0]
    v_cvt_pk_bf16_f32 v94, v108, v109
    v_cvt_pk_bf16_f32 v95, v110, v111
    s_waitcnt lgkmcnt(0)
    s_nop 0
    v_mfma_f32_16x16x32_bf16 v[56:59], a[96:99], v[92:95], v[56:59]
    v_mfma_f32_16x16x32_bf16 v[60:63], a[100:103], v[92:95], v[60:63]
    s_add_u32 m0, s58, 24576
    s_add_u32 s73, s77, 688128
    buffer_load_dwordx4 v29, s[16:19], s73 offen lds
    v_mfma_f32_16x16x32_bf16 v[64:67], a[104:107], v[92:95], v[64:67]
    v_mfma_f32_16x16x32_bf16 v[68:71], a[108:111], v[92:95], v[68:71]
    s_waitcnt vmcnt(10)
    v_mfma_f32_16x16x32_bf16 v[116:119], a[76:79], a[12:15], 0
    v_mfma_f32_16x16x16_bf16 v[104:107], a[44:45], a[12:13], 0
    v_mfma_f32_16x16x16_bf16 v[108:111], a[46:47], a[14:15], 0
    ds_read_b64_tr_b16 a[96:97], v120 offset:8192
    ds_read_b64_tr_b16 a[98:99], v120 offset:10240
    ds_read_b64_tr_b16 a[100:101], v121 offset:8192
    ds_read_b64_tr_b16 a[102:103], v121 offset:10240
    ds_read_b64_tr_b16 a[104:105], v122 offset:8192
    ds_read_b64_tr_b16 a[106:107], v122 offset:10240
    ds_read_b64_tr_b16 a[108:109], v123 offset:8192
    ds_read_b64_tr_b16 a[110:111], v123 offset:10240
    v_cvt_pk_bf16_f32 v7, v112, v113
    v_lshlrev_b32 v112, 16, v7
    v_and_b32 v113, 4294901760, v7
    v_pk_add_f32 v[112:113], v[112:113], s[54:55]
    s_add_u32 m0, s58, 32768
    s_add_u32 s73, s77, 917504
    buffer_load_dwordx4 v29, s[16:19], s73 offen lds
    v_cvt_pk_bf16_f32 v7, v112, v113
    v_lshlrev_b32 v112, 16, v7
    v_and_b32 v113, 4294901760, v7
    v_rcp_f32 v114, v113
    v_rcp_f32 v112, v112
    s_nop 0
    v_pk_mul_f32 v[96:97], v[96:97], v[112:113] op_sel_hi:[1,0]
    v_pk_mul_f32 v[98:99], v[98:99], v[112:113] op_sel_hi:[1,0]
    v_cvt_pk_bf16_f32 v88, v96, v97
    v_cvt_pk_bf16_f32 v89, v98, v99
    v_pk_mul_f32 v[100:101], v[100:101], v[114:115] op_sel_hi:[1,0]
    v_pk_mul_f32 v[102:103], v[102:103], v[114:115] op_sel_hi:[1,0]
    v_cvt_pk_bf16_f32 v90, v100, v101
    v_cvt_pk_bf16_f32 v91, v102, v103
    s_waitcnt lgkmcnt(0)
    s_nop 0
    v_mfma_f32_16x16x32_bf16 v[56:59], a[96:99], v[88:91], v[56:59]
    v_mfma_f32_16x16x32_bf16 v[60:63], a[100:103], v[88:91], v[60:63]
    v_mfma_f32_16x16x32_bf16 v[64:67], a[104:107], v[88:91], v[64:67]
    s_add_u32 m0, s58, 40960
    s_add_u32 s73, s77, 1146880
    buffer_load_dwordx4 v29, s[16:19], s73 offen lds
    v_mfma_f32_16x16x32_bf16 v[68:71], a[108:111], v[88:91], v[68:71]
    s_waitcnt vmcnt(11)
    v_mfma_f32_16x16x32_bf16 v[112:115], a[80:83], a[16:19], 0
    v_mfma_f32_16x16x16_bf16 v[96:99], a[48:49], a[16:17], 0
    v_mfma_f32_16x16x16_bf16 v[100:103], a[50:51], a[18:19], 0
    ds_read_b64_tr_b16 a[96:97], v120 offset:12288
    ds_read_b64_tr_b16 a[98:99], v120 offset:14336
    ds_read_b64_tr_b16 a[100:101], v121 offset:12288
    ds_read_b64_tr_b16 a[102:103], v121 offset:14336
    ds_read_b64_tr_b16 a[104:105], v122 offset:12288
    ds_read_b64_tr_b16 a[106:107], v122 offset:14336
    ds_read_b64_tr_b16 a[108:109], v123 offset:12288
    ds_read_b64_tr_b16 a[110:111], v123 offset:14336
    v_cvt_pk_bf16_f32 v7, v116, v117
    v_lshlrev_b32 v116, 16, v7
    v_and_b32 v117, 4294901760, v7
    v_pk_add_f32 v[116:117], v[116:117], s[54:55]
    v_cvt_pk_bf16_f32 v7, v116, v117
    v_lshlrev_b32 v116, 16, v7
    v_and_b32 v117, 4294901760, v7
    v_rcp_f32 v118, v117
    s_add_u32 m0, s58, 49152
    s_add_u32 s73, s77, 1376256
    buffer_load_dwordx4 v29, s[16:19], s73 offen lds
    v_rcp_f32 v116, v116
    s_nop 0
    v_pk_mul_f32 v[104:105], v[104:105], v[116:117] op_sel_hi:[1,0]
    v_pk_mul_f32 v[106:107], v[106:107], v[116:117] op_sel_hi:[1,0]
    v_cvt_pk_bf16_f32 v92, v104, v105
    v_cvt_pk_bf16_f32 v93, v106, v107
    v_pk_mul_f32 v[108:109], v[108:109], v[118:119] op_sel_hi:[1,0]
    v_pk_mul_f32 v[110:111], v[110:111], v[118:119] op_sel_hi:[1,0]
    v_cvt_pk_bf16_f32 v94, v108, v109
    v_cvt_pk_bf16_f32 v95, v110, v111
    s_waitcnt lgkmcnt(0)
    s_nop 0
    v_mfma_f32_16x16x32_bf16 v[56:59], a[96:99], v[92:95], v[56:59]
    v_mfma_f32_16x16x32_bf16 v[60:63], a[100:103], v[92:95], v[60:63]
    v_mfma_f32_16x16x32_bf16 v[64:67], a[104:107], v[92:95], v[64:67]
    v_mfma_f32_16x16x32_bf16 v[68:71], a[108:111], v[92:95], v[68:71]
    s_add_u32 m0, s58, 57344
    s_add_u32 s73, s77, 1605632
    buffer_load_dwordx4 v29, s[16:19], s73 offen lds
    s_waitcnt vmcnt(12)
    v_mfma_f32_16x16x32_bf16 v[116:119], a[84:87], a[20:23], 0
    v_mfma_f32_16x16x16_bf16 v[104:107], a[52:53], a[20:21], 0
    v_mfma_f32_16x16x16_bf16 v[108:111], a[54:55], a[22:23], 0
    ds_read_b64_tr_b16 a[96:97], v120 offset:16384
    ds_read_b64_tr_b16 a[98:99], v120 offset:18432
    ds_read_b64_tr_b16 a[100:101], v121 offset:16384
    ds_read_b64_tr_b16 a[102:103], v121 offset:18432
    ds_read_b64_tr_b16 a[104:105], v122 offset:16384
    ds_read_b64_tr_b16 a[106:107], v122 offset:18432
    ds_read_b64_tr_b16 a[108:109], v123 offset:16384
    ds_read_b64_tr_b16 a[110:111], v123 offset:18432
    v_cvt_pk_bf16_f32 v7, v112, v113
    v_lshlrev_b32 v112, 16, v7
    v_and_b32 v113, 4294901760, v7
    v_pk_add_f32 v[112:113], v[112:113], s[54:55]
    v_cvt_pk_bf16_f32 v7, v112, v113
    v_lshlrev_b32 v112, 16, v7
    v_and_b32 v113, 4294901760, v7
    v_rcp_f32 v114, v113
    v_rcp_f32 v112, v112
    s_nop 0
    v_pk_mul_f32 v[96:97], v[96:97], v[112:113] op_sel_hi:[1,0]
    v_pk_mul_f32 v[98:99], v[98:99], v[112:113] op_sel_hi:[1,0]
    v_cvt_pk_bf16_f32 v88, v96, v97
    v_cvt_pk_bf16_f32 v89, v98, v99
    v_pk_mul_f32 v[100:101], v[100:101], v[114:115] op_sel_hi:[1,0]
    v_pk_mul_f32 v[102:103], v[102:103], v[114:115] op_sel_hi:[1,0]
    v_cvt_pk_bf16_f32 v90, v100, v101
    v_cvt_pk_bf16_f32 v91, v102, v103
    s_waitcnt lgkmcnt(0)
    s_nop 0
    v_mfma_f32_16x16x32_bf16 v[56:59], a[96:99], v[88:91], v[56:59]
    v_mfma_f32_16x16x32_bf16 v[60:63], a[100:103], v[88:91], v[60:63]
    v_mfma_f32_16x16x32_bf16 v[64:67], a[104:107], v[88:91], v[64:67]
    v_mfma_f32_16x16x32_bf16 v[68:71], a[108:111], v[88:91], v[68:71]
    s_waitcnt vmcnt(11)
    v_mfma_f32_16x16x32_bf16 v[112:115], a[88:91], a[24:27], 0
    v_mfma_f32_16x16x16_bf16 v[96:99], a[56:57], a[24:25], 0
    v_mfma_f32_16x16x16_bf16 v[100:103], a[58:59], a[26:27], 0
    ds_read_b64_tr_b16 a[96:97], v120 offset:20480
    ds_read_b64_tr_b16 a[98:99], v120 offset:22528
    ds_read_b64_tr_b16 a[100:101], v121 offset:20480
    ds_read_b64_tr_b16 a[102:103], v121 offset:22528
    ds_read_b64_tr_b16 a[104:105], v122 offset:20480
    ds_read_b64_tr_b16 a[106:107], v122 offset:22528
    ds_read_b64_tr_b16 a[108:109], v123 offset:20480
    ds_read_b64_tr_b16 a[110:111], v123 offset:22528
    v_cvt_pk_bf16_f32 v7, v116, v117
    v_lshlrev_b32 v116, 16, v7
    v_and_b32 v117, 4294901760, v7
    v_pk_add_f32 v[116:117], v[116:117], s[54:55]
    v_cvt_pk_bf16_f32 v7, v116, v117
    v_lshlrev_b32 v116, 16, v7
    v_and_b32 v117, 4294901760, v7
    v_rcp_f32 v118, v117
    v_rcp_f32 v116, v116
    s_nop 0
    v_pk_mul_f32 v[104:105], v[104:105], v[116:117] op_sel_hi:[1,0]
    v_pk_mul_f32 v[106:107], v[106:107], v[116:117] op_sel_hi:[1,0]
    v_cvt_pk_bf16_f32 v92, v104, v105
    v_cvt_pk_bf16_f32 v93, v106, v107
    v_pk_mul_f32 v[108:109], v[108:109], v[118:119] op_sel_hi:[1,0]
    v_pk_mul_f32 v[110:111], v[110:111], v[118:119] op_sel_hi:[1,0]
    v_cvt_pk_bf16_f32 v94, v108, v109
    v_cvt_pk_bf16_f32 v95, v110, v111
    s_waitcnt lgkmcnt(0)
    s_nop 0
    v_mfma_f32_16x16x32_bf16 v[56:59], a[96:99], v[92:95], v[56:59]
    v_mfma_f32_16x16x32_bf16 v[60:63], a[100:103], v[92:95], v[60:63]
    v_mfma_f32_16x16x32_bf16 v[64:67], a[104:107], v[92:95], v[64:67]
    v_mfma_f32_16x16x32_bf16 v[68:71], a[108:111], v[92:95], v[68:71]
    s_waitcnt vmcnt(10)
    v_mfma_f32_16x16x32_bf16 v[116:119], a[92:95], a[28:31], 0
    v_mfma_f32_16x16x16_bf16 v[104:107], a[60:61], a[28:29], 0
    v_mfma_f32_16x16x16_bf16 v[108:111], a[62:63], a[30:31], 0
    ds_read_b64_tr_b16 a[96:97], v120 offset:24576
    ds_read_b64_tr_b16 a[98:99], v120 offset:26624
    ds_read_b64_tr_b16 a[100:101], v121 offset:24576
    ds_read_b64_tr_b16 a[102:103], v121 offset:26624
    ds_read_b64_tr_b16 a[104:105], v122 offset:24576
    ds_read_b64_tr_b16 a[106:107], v122 offset:26624
    ds_read_b64_tr_b16 a[108:109], v123 offset:24576
    ds_read_b64_tr_b16 a[110:111], v123 offset:26624
    v_cvt_pk_bf16_f32 v7, v112, v113
    v_lshlrev_b32 v112, 16, v7
    v_and_b32 v113, 4294901760, v7
    v_pk_add_f32 v[112:113], v[112:113], s[54:55]
    v_cvt_pk_bf16_f32 v7, v112, v113
    v_lshlrev_b32 v112, 16, v7
    v_and_b32 v113, 4294901760, v7
    v_rcp_f32 v114, v113
    v_rcp_f32 v112, v112
    s_nop 0
    v_pk_mul_f32 v[96:97], v[96:97], v[112:113] op_sel_hi:[1,0]
    v_pk_mul_f32 v[98:99], v[98:99], v[112:113] op_sel_hi:[1,0]
    v_cvt_pk_bf16_f32 v88, v96, v97
    v_cvt_pk_bf16_f32 v89, v98, v99
    v_pk_mul_f32 v[100:101], v[100:101], v[114:115] op_sel_hi:[1,0]
    v_pk_mul_f32 v[102:103], v[102:103], v[114:115] op_sel_hi:[1,0]
    v_cvt_pk_bf16_f32 v90, v100, v101
    v_cvt_pk_bf16_f32 v91, v102, v103
    s_waitcnt lgkmcnt(0)
    s_nop 0
    v_mfma_f32_16x16x32_bf16 v[56:59], a[96:99], v[88:91], v[56:59]
    v_mfma_f32_16x16x32_bf16 v[60:63], a[100:103], v[88:91], v[60:63]
    v_mfma_f32_16x16x32_bf16 v[64:67], a[104:107], v[88:91], v[64:67]
    v_mfma_f32_16x16x32_bf16 v[68:71], a[108:111], v[88:91], v[68:71]
    ds_read_b64_tr_b16 a[96:97], v120 offset:28672
    ds_read_b64_tr_b16 a[98:99], v120 offset:30720
    ds_read_b64_tr_b16 a[100:101], v121 offset:28672
    ds_read_b64_tr_b16 a[102:103], v121 offset:30720
    ds_read_b64_tr_b16 a[104:105], v122 offset:28672
    ds_read_b64_tr_b16 a[106:107], v122 offset:30720
    ds_read_b64_tr_b16 a[108:109], v123 offset:28672
    ds_read_b64_tr_b16 a[110:111], v123 offset:30720
    v_cvt_pk_bf16_f32 v7, v116, v117
    v_lshlrev_b32 v116, 16, v7
    v_and_b32 v117, 4294901760, v7
    v_pk_add_f32 v[116:117], v[116:117], s[54:55]
    v_cvt_pk_bf16_f32 v7, v116, v117
    v_lshlrev_b32 v116, 16, v7
    v_and_b32 v117, 4294901760, v7
    v_rcp_f32 v118, v117
    v_rcp_f32 v116, v116
    s_nop 0
    v_pk_mul_f32 v[104:105], v[104:105], v[116:117] op_sel_hi:[1,0]
    v_pk_mul_f32 v[106:107], v[106:107], v[116:117] op_sel_hi:[1,0]
    v_cvt_pk_bf16_f32 v92, v104, v105
    v_cvt_pk_bf16_f32 v93, v106, v107
    v_pk_mul_f32 v[108:109], v[108:109], v[118:119] op_sel_hi:[1,0]
    v_pk_mul_f32 v[110:111], v[110:111], v[118:119] op_sel_hi:[1,0]
    v_cvt_pk_bf16_f32 v94, v108, v109
    v_cvt_pk_bf16_f32 v95, v110, v111
    s_waitcnt lgkmcnt(0)
    s_nop 0
    v_mfma_f32_16x16x32_bf16 v[56:59], a[96:99], v[92:95], v[56:59]
    v_mfma_f32_16x16x32_bf16 v[60:63], a[100:103], v[92:95], v[60:63]
    v_mfma_f32_16x16x32_bf16 v[64:67], a[104:107], v[92:95], v[64:67]
    v_mfma_f32_16x16x32_bf16 v[68:71], a[108:111], v[92:95], v[68:71]
    s_barrier
    s_mul_i32 s39, s36, 2048
    s_add_u32 s39, s39, 65536
    v_add_u32 v124, s39, v4
    s_nop 2
    ds_write_b128 v124, v[64:67]
    ds_write_b128 v124, v[68:71] offset:1024
    s_xor_b32 s39, s36, 1
    s_mul_i32 s39, s39, 2048
    s_add_u32 s39, s39, 65536
    s_waitcnt lgkmcnt(0)
    s_barrier
    v_add_u32 v124, s39, v4
    ds_read_b128 v[96:99], v124
    ds_read_b128 v[100:103], v124 offset:1024
    s_waitcnt lgkmcnt(1)
    v_pk_add_f32 v[56:57], v[56:57], v[96:97]
    v_pk_add_f32 v[58:59], v[58:59], v[98:99]
    s_waitcnt lgkmcnt(0)
    v_pk_add_f32 v[60:61], v[60:61], v[100:101]
    v_pk_add_f32 v[62:63], v[62:63], v[102:103]
    s_waitcnt vmcnt(8)
    v_cvt_pk_bf16_f32 v7, v56, v57
    v_lshlrev_b32 v56, 16, v7
    v_and_b32 v57, 4294901760, v7
    v_lshlrev_b32 v26, 16, v80
    v_and_b32 v27, 4294901760, v80
    v_pk_add_f32 v[56:57], v[56:57], v[26:27]
    v_cvt_pk_bf16_f32 v128, v56, v57
    v_cvt_pk_bf16_f32 v7, v58, v59
    v_lshlrev_b32 v58, 16, v7
    v_and_b32 v59, 4294901760, v7
    v_lshlrev_b32 v26, 16, v81
    v_and_b32 v27, 4294901760, v81
    v_pk_add_f32 v[58:59], v[58:59], v[26:27]
    v_cvt_pk_bf16_f32 v129, v58, v59
    v_cvt_pk_bf16_f32 v7, v60, v61
    v_lshlrev_b32 v60, 16, v7
    v_and_b32 v61, 4294901760, v7
    v_lshlrev_b32 v26, 16, v82
    v_and_b32 v27, 4294901760, v82
    v_pk_add_f32 v[60:61], v[60:61], v[26:27]
    v_cvt_pk_bf16_f32 v130, v60, v61
    v_cvt_pk_bf16_f32 v7, v62, v63
    v_lshlrev_b32 v62, 16, v7
    v_and_b32 v63, 4294901760, v7
    v_lshlrev_b32 v26, 16, v83
    v_and_b32 v27, 4294901760, v83
    v_pk_add_f32 v[62:63], v[62:63], v[26:27]
    v_cvt_pk_bf16_f32 v131, v62, v63
    s_lshl_b32 s90, s63, 4
    s_add_u32 s90, s90, s65
    s_lshl_b32 s90, s90, 10
    s_add_u32 s90, s90, 0x400000
    buffer_store_dwordx4 v[128:131], v4, s[32:35], s90 offen sc1
    v_lshlrev_b32 v5, 16, v128
    v_and_b32 v6, 4294901760, v128
    v_add_f32 v132, v5, v6
    v_mul_f32 v133, v5, v5
    v_fmac_f32 v133, v6, v6
    v_lshlrev_b32 v5, 16, v129
    v_and_b32 v6, 4294901760, v129
    v_add_f32 v132, v132, v5
    v_add_f32 v132, v132, v6
    v_fmac_f32 v133, v5, v5
    v_fmac_f32 v133, v6, v6
    v_lshlrev_b32 v5, 16, v130
    v_and_b32 v6, 4294901760, v130
    v_add_f32 v132, v132, v5
    v_add_f32 v132, v132, v6
    v_fmac_f32 v133, v5, v5
    v_fmac_f32 v133, v6, v6
    v_lshlrev_b32 v5, 16, v131
    v_and_b32 v6, 4294901760, v131
    v_add_f32 v132, v132, v5
    v_add_f32 v132, v132, v6
    v_fmac_f32 v133, v5, v5
    v_fmac_f32 v133, v6, v6
    v_mov_b32 v5, v132
    v_mov_b32 v6, v133
    s_nop 0
    v_permlane32_swap_b32 v5, v132
    v_permlane32_swap_b32 v6, v133
    v_add_f32 v132, v132, v5
    v_add_f32 v133, v133, v6
    v_mov_b32 v5, v132
    v_mov_b32 v6, v133
    s_nop 0
    v_permlane16_swap_b32 v5, v132
    v_permlane16_swap_b32 v6, v133
    v_add_f32 v134, v132, v5
    v_add_f32 v135, v133, v6
    v_lshlrev_b32 v136, 7, v2
    v_mov_b32 v5, 0x7ff00000
    v_cmp_eq_u32 vcc, 0, v3
    s_nop 1
    v_cndmask_b32 v136, v5, v136, vcc
    s_lshl_b32 s91, s63, 11
    s_lshl_b32 s41, s65, 3
    s_add_u32 s91, s91, s41
    s_add_u32 s91, s91, 0x1b00000
    buffer_store_dwordx2 v[134:135], v136, s[32:35], s91 offen sc1
    v_lshlrev_b32 v58, 7, v2
    v_lshl_add_u32 v58, v3, 5, v58
    s_lshl_b32 s82, s61, 11
    s_add_u32 s82, s82, 0x1b00000
    s_mul_i32 s83, s61, 16
    s_mul_i32 s40, s62, 8
    s_add_u32 s83, s83, s40
    s_lshl_b32 s83, s83, 10
    s_add_u32 s83, s83, 0x400000
    s_add_u32 s84, s83, 4096
    s_xor_b32 s39, s61, 1
    s_mul_i32 s85, s39, 16
    s_mul_i32 s40, s62, 8
    s_add_u32 s85, s85, s40
    s_lshl_b32 s85, s85, 10
    s_add_u32 s85, s85, 0x400000
    s_add_u32 s86, s85, 4096
    s_waitcnt vmcnt(0)
    s_barrier
    buffer_atomic_add v9, v11, s[32:35], s44 offen sc1
    s_add_u32 m0, s79, 98304
    s_add_u32 s73, s78, 0
    buffer_load_dwordx4 v32, s[16:19], s73 offen lds
    s_add_u32 m0, s79, 99328
    s_add_u32 s73, s78, 0
    buffer_load_dwordx4 v33, s[16:19], s73 offen lds
    s_add_u32 m0, s79, 100352
    s_add_u32 s73, s78, 0
    buffer_load_dwordx4 v34, s[16:19], s73 offen lds
    s_add_u32 m0, s79, 122880
    s_add_u32 s73, s78, 917504
    buffer_load_dwordx4 v32, s[16:19], s73 offen lds
    s_add_u32 m0, s79, 123904
    s_add_u32 s73, s78, 917504
    buffer_load_dwordx4 v33, s[16:19], s73 offen lds
    s_add_u32 m0, s79, 124928
    s_add_u32 s73, s78, 917504
    buffer_load_dwordx4 v34, s[16:19], s73 offen lds
    s_mov_b32 s60, 0
    s_cmp_lg_u32 s36, 0
    s_nop 3
    s_cbranch_scc1 Linterleave_layers__linear_attn_block__dense_activation_silu__prompt_kernel_13
Linterleave_layers__linear_attn_block__dense_activation_silu__prompt_kernel_12:
    buffer_load_dword v13, v10, s[32:35], s44 offen sc1
    s_waitcnt vmcnt(0)
    v_readfirstlane_b32 s39, v13
    s_nop 4
    s_cmp_ge_u32 s39, 32
    s_cbranch_scc1 Linterleave_layers__linear_attn_block__dense_activation_silu__prompt_kernel_13
    s_sleep 2
    s_add_u32 s60, s60, 1
    s_cmp_lt_u32 s60, 0x40000
    s_cbranch_scc1 Linterleave_layers__linear_attn_block__dense_activation_silu__prompt_kernel_12
Linterleave_layers__linear_attn_block__dense_activation_silu__prompt_kernel_13:
    s_nop 3
    s_waitcnt vmcnt(0)
    s_barrier
    buffer_load_dwordx4 a[0:3], v4, s[32:35], s83 offen sc1
    buffer_load_dwordx4 a[32:35], v4, s[32:35], s85 offen sc1
    buffer_load_dwordx4 v[60:63], v58, s[32:35], s82 offen sc1
    buffer_load_dwordx4 v[64:67], v58, s[32:35], s82 offen offset:16 sc1
    buffer_load_dwordx4 a[4:7], v4, s[32:35], s83 offen offset:1024 sc1
    buffer_load_dwordx4 a[36:39], v4, s[32:35], s85 offen offset:1024 sc1
    buffer_load_dwordx4 a[8:11], v4, s[32:35], s83 offen offset:2048 sc1
    buffer_load_dwordx4 a[40:43], v4, s[32:35], s85 offen offset:2048 sc1
    buffer_load_dwordx4 a[12:15], v4, s[32:35], s83 offen offset:3072 sc1
    buffer_load_dwordx4 a[44:47], v4, s[32:35], s85 offen offset:3072 sc1
    s_min_u32 s88, s36, 6
    v_add_u32 v68, 0, v35
    s_mov_b32 s87, 4096
    s_mov_b32 s89, 2048
    s_cmp_lg_u32 s88, 1
    s_cbranch_scc1 Linterleave_layers__linear_attn_block__dense_activation_silu__prompt_kernel_14
    v_add_u32 v68, 0, v36
Linterleave_layers__linear_attn_block__dense_activation_silu__prompt_kernel_14:
    s_cmp_lg_u32 s88, 2
    s_cbranch_scc1 Linterleave_layers__linear_attn_block__dense_activation_silu__prompt_kernel_15
    v_add_u32 v68, 0, v37
Linterleave_layers__linear_attn_block__dense_activation_silu__prompt_kernel_15:
    s_cmp_lg_u32 s88, 3
    s_cbranch_scc1 Linterleave_layers__linear_attn_block__dense_activation_silu__prompt_kernel_16
    v_add_u32 v68, 0, v38
Linterleave_layers__linear_attn_block__dense_activation_silu__prompt_kernel_16:
    s_cmp_lg_u32 s88, 4
    s_cbranch_scc1 Linterleave_layers__linear_attn_block__dense_activation_silu__prompt_kernel_17
    v_add_u32 v68, 98304, v45
    s_mov_b32 s87, 3072
    s_mov_b32 s89, 1536
Linterleave_layers__linear_attn_block__dense_activation_silu__prompt_kernel_17:
    s_cmp_lg_u32 s88, 5
    s_cbranch_scc1 Linterleave_layers__linear_attn_block__dense_activation_silu__prompt_kernel_18
    v_add_u32 v68, 98336, v45
    s_mov_b32 s87, 3072
    s_mov_b32 s89, 1536
Linterleave_layers__linear_attn_block__dense_activation_silu__prompt_kernel_18:
    s_cmp_lg_u32 s88, 6
    s_cbranch_scc1 Linterleave_layers__linear_attn_block__dense_activation_silu__prompt_kernel_19
    v_add_u32 v68, 98368, v45
    s_mov_b32 s87, 3072
    s_mov_b32 s89, 1536
Linterleave_layers__linear_attn_block__dense_activation_silu__prompt_kernel_19:
    s_nop 3
    v_add_u32 v69, s89, v68
    ds_read_b64_tr_b16 a[64:65], v68
    ds_read_b64_tr_b16 a[66:67], v69
    v_add_u32 v68, s87, v68
    v_add_u32 v69, s87, v69
    ds_read_b64_tr_b16 a[68:69], v68
    ds_read_b64_tr_b16 a[70:71], v69
    v_add_u32 v68, s87, v68
    v_add_u32 v69, s87, v69
    ds_read_b64_tr_b16 a[72:73], v68
    ds_read_b64_tr_b16 a[74:75], v69
    v_add_u32 v68, s87, v68
    v_add_u32 v69, s87, v69
    ds_read_b64_tr_b16 a[76:77], v68
    ds_read_b64_tr_b16 a[78:79], v69
    v_add_u32 v68, s87, v68
    v_add_u32 v69, s87, v69
    ds_read_b64_tr_b16 a[80:81], v68
    ds_read_b64_tr_b16 a[82:83], v69
    v_add_u32 v68, s87, v68
    v_add_u32 v69, s87, v69
    s_waitcnt lgkmcnt(8)
    v_mfma_f32_16x16x32_bf16 v[72:75], v[16:19], a[64:67], 0
    ds_read_b64_tr_b16 a[84:85], v68
    ds_read_b64_tr_b16 a[86:87], v69
    v_add_u32 v68, s87, v68
    v_add_u32 v69, s87, v69
    s_waitcnt lgkmcnt(8)
    v_mfma_f32_16x16x32_bf16 v[72:75], v[16:19], a[68:71], v[72:75]
    ds_read_b64_tr_b16 a[88:89], v68
    ds_read_b64_tr_b16 a[90:91], v69
    v_add_u32 v68, s87, v68
    v_add_u32 v69, s87, v69
    s_waitcnt lgkmcnt(8)
    v_mfma_f32_16x16x32_bf16 v[72:75], v[16:19], a[72:75], v[72:75]
    ds_read_b64_tr_b16 a[92:93], v68
    ds_read_b64_tr_b16 a[94:95], v69
    v_add_u32 v68, s87, v68
    v_add_u32 v69, s87, v69
    s_waitcnt lgkmcnt(8)
    v_mfma_f32_16x16x32_bf16 v[72:75], v[16:19], a[76:79], v[72:75]
    ds_read_b64_tr_b16 a[64:65], v68
    ds_read_b64_tr_b16 a[66:67], v69
    v_add_u32 v68, s87, v68
    v_add_u32 v69, s87, v69
    s_waitcnt lgkmcnt(8)
    v_mfma_f32_16x16x32_bf16 v[72:75], v[16:19], a[80:83], v[72:75]
    ds_read_b64_tr_b16 a[68:69], v68
    ds_read_b64_tr_b16 a[70:71], v69
    v_add_u32 v68, s87, v68
    v_add_u32 v69, s87, v69
    s_waitcnt lgkmcnt(8)
    v_mfma_f32_16x16x32_bf16 v[72:75], v[16:19], a[84:87], v[72:75]
    ds_read_b64_tr_b16 a[72:73], v68
    ds_read_b64_tr_b16 a[74:75], v69
    v_add_u32 v68, s87, v68
    v_add_u32 v69, s87, v69
    s_waitcnt lgkmcnt(8)
    v_mfma_f32_16x16x32_bf16 v[72:75], v[16:19], a[88:91], v[72:75]
    ds_read_b64_tr_b16 a[76:77], v68
    ds_read_b64_tr_b16 a[78:79], v69
    v_add_u32 v68, s87, v68
    v_add_u32 v69, s87, v69
    s_waitcnt lgkmcnt(8)
    v_mfma_f32_16x16x32_bf16 v[72:75], v[16:19], a[92:95], v[72:75]
    ds_read_b64_tr_b16 a[80:81], v68
    ds_read_b64_tr_b16 a[82:83], v69
    v_add_u32 v68, s87, v68
    v_add_u32 v69, s87, v69
    s_waitcnt lgkmcnt(8)
    v_mfma_f32_16x16x32_bf16 v[72:75], v[16:19], a[64:67], v[72:75]
    ds_read_b64_tr_b16 a[84:85], v68
    ds_read_b64_tr_b16 a[86:87], v69
    v_add_u32 v68, s87, v68
    v_add_u32 v69, s87, v69
    s_waitcnt lgkmcnt(8)
    v_mfma_f32_16x16x32_bf16 v[72:75], v[16:19], a[68:71], v[72:75]
    ds_read_b64_tr_b16 a[88:89], v68
    ds_read_b64_tr_b16 a[90:91], v69
    v_add_u32 v68, s87, v68
    v_add_u32 v69, s87, v69
    s_waitcnt lgkmcnt(8)
    v_mfma_f32_16x16x32_bf16 v[72:75], v[16:19], a[72:75], v[72:75]
    ds_read_b64_tr_b16 a[92:93], v68
    ds_read_b64_tr_b16 a[94:95], v69
    s_waitcnt lgkmcnt(8)
    v_mfma_f32_16x16x32_bf16 v[72:75], v[16:19], a[76:79], v[72:75]
    s_waitcnt lgkmcnt(6)
    v_mfma_f32_16x16x32_bf16 v[72:75], v[16:19], a[80:83], v[72:75]
    s_waitcnt lgkmcnt(4)
    v_mfma_f32_16x16x32_bf16 v[72:75], v[16:19], a[84:87], v[72:75]
    s_waitcnt lgkmcnt(2)
    v_mfma_f32_16x16x32_bf16 v[72:75], v[16:19], a[88:91], v[72:75]
    s_waitcnt lgkmcnt(0)
    v_mfma_f32_16x16x32_bf16 v[72:75], v[16:19], a[92:95], v[72:75]
    s_lshl_b32 s88, s88, 6
    s_add_u32 s88, s88, 147840
    v_add_u32 v68, s88, v14
    s_nop 4
    ds_write_b32 v68, v72
    s_waitcnt vmcnt(6)
    v_add_f32 v68, v60, v62
    v_add_f32 v69, v61, v63
    v_add_f32 v64, v64, v66
    v_add_f32 v65, v65, v67
    v_add_f32 v68, v68, v64
    v_add_f32 v69, v69, v65
    v_mov_b32 v5, v68
    v_mov_b32 v6, v69
    s_nop 0
    v_permlane32_swap_b32 v5, v68
    v_permlane32_swap_b32 v6, v69
    v_add_f32 v68, v68, v5
    v_add_f32 v69, v69, v6
    v_mov_b32 v5, v68
    v_mov_b32 v6, v69
    s_nop 0
    v_permlane16_swap_b32 v5, v68
    v_permlane16_swap_b32 v6, v69
    v_add_f32 v70, v68, v5
    v_add_f32 v71, v69, v6
    v_mul_f32 v70, 0x3b000000, v70
    v_mul_f32 v71, 0x3b000000, v71
    v_fma_f32 v71, -v70, v70, v71
    v_max_f32 v71, 0, v71
    v_cvt_pk_bf16_f32 v7, v70, v71
    v_lshlrev_b32 v70, 16, v7
    v_and_b32 v71, 4294901760, v7
    v_add_f32 v71, 0x3727c5ac, v71
    v_cvt_pk_bf16_f32 v7, v71, v71
    v_lshlrev_b32 v71, 16, v7
    v_sqrt_f32 v71, v71
    s_nop 0
    v_cvt_pk_bf16_f32 v7, v71, v71
    v_lshlrev_b32 v71, 16, v7
    v_rcp_f32 v71, v71
    v_sub_f32 v70, 0, v70
    v_mov_b32 v54, v70
    v_mov_b32 v56, v71
    s_lshl_b32 s39, s62, 15
    v_add_u32 v116, s39, v35
    v_add_u32 v117, s39, v36
    v_add_u32 v118, s39, v37
    v_add_u32 v119, s39, v38
    s_mul_i32 s39, s62, 24576
    s_add_u32 s39, s39, 98304
    v_add_u32 v120, s39, v45
    s_mul_i32 s87, s61, 56
    s_lshr_b32 s39, s43, 1
    s_mul_i32 s39, s39, 7
    s_add_u32 s87, s87, s39
    s_and_b32 s40, s43, 1
    s_add_u32 s88, s87, 6
    s_lshl_b32 s88, s88, 10
    s_lshl_b32 s39, s40, 3
    s_add_u32 s88, s88, s39
    s_add_u32 s88, s88, 0xa00000
    s_mul_i32 s39, s40, 3
    s_add_u32 s87, s87, s39
    s_lshl_b32 s87, s87, 10
    s_add_u32 s87, s87, 0xa00000
    ds_read_b64_tr_b16 a[64:65], v116
    ds_read_b64_tr_b16 a[66:67], v116 offset:2048
    ds_read_b64_tr_b16 a[68:69], v117
    ds_read_b64_tr_b16 a[70:71], v117 offset:2048
    ds_read_b64_tr_b16 a[72:73], v118
    ds_read_b64_tr_b16 a[74:75], v118 offset:2048
    ds_read_b64_tr_b16 a[76:77], v119
    ds_read_b64_tr_b16 a[78:79], v119 offset:2048
    ds_read_b64_tr_b16 a[80:81], v120
    ds_read_b64_tr_b16 a[82:83], v120 offset:1536
    ds_read_b64_tr_b16 a[84:85], v120 offset:32
    ds_read_b64_tr_b16 a[86:87], v120 offset:1568
    ds_read_b64_tr_b16 a[88:89], v120 offset:64
    ds_read_b64_tr_b16 a[90:91], v120 offset:1600
    buffer_load_dwordx4 a[16:19], v4, s[32:35], s84 offen sc1
    buffer_load_dwordx4 a[48:51], v4, s[32:35], s86 offen sc1
    s_waitcnt lgkmcnt(6)
    v_mfma_f32_16x16x32_bf16 v[60:63], a[64:67], a[0:3], 0
    ds_read_b64_tr_b16 a[96:97], v116 offset:4096
    v_mfma_f32_16x16x32_bf16 v[88:91], a[64:67], a[32:35], 0
    ds_read_b64_tr_b16 a[98:99], v116 offset:6144
    v_mfma_f32_16x16x32_bf16 v[64:67], a[68:71], a[0:3], 0
    ds_read_b64_tr_b16 a[100:101], v117 offset:4096
    v_mfma_f32_16x16x32_bf16 v[92:95], a[68:71], a[32:35], 0
    ds_read_b64_tr_b16 a[102:103], v117 offset:6144
    v_mfma_f32_16x16x32_bf16 v[68:71], a[72:75], a[0:3], 0
    ds_read_b64_tr_b16 a[104:105], v118 offset:4096
    v_mfma_f32_16x16x32_bf16 v[96:99], a[72:75], a[32:35], 0
    ds_read_b64_tr_b16 a[106:107], v118 offset:6144
    v_mfma_f32_16x16x32_bf16 v[72:75], a[76:79], a[0:3], 0
    ds_read_b64_tr_b16 a[108:109], v119 offset:4096
    v_mfma_f32_16x16x32_bf16 v[100:103], a[76:79], a[32:35], 0
    ds_read_b64_tr_b16 a[110:111], v119 offset:6144
    s_waitcnt lgkmcnt(8)
    v_mfma_f32_16x16x32_bf16 v[76:79], a[80:83], a[0:3], 0
    ds_read_b64_tr_b16 a[64:65], v120 offset:3072
    v_mfma_f32_16x16x32_bf16 v[104:107], a[80:83], a[32:35], 0
    ds_read_b64_tr_b16 a[66:67], v120 offset:4608
    v_mfma_f32_16x16x32_bf16 v[80:83], a[84:87], a[0:3], 0
    ds_read_b64_tr_b16 a[68:69], v120 offset:3104
    v_mfma_f32_16x16x32_bf16 v[108:111], a[84:87], a[32:35], 0
    ds_read_b64_tr_b16 a[70:71], v120 offset:4640
    v_mfma_f32_16x16x32_bf16 v[84:87], a[88:91], a[0:3], 0
    ds_read_b64_tr_b16 a[72:73], v120 offset:3136
    v_mfma_f32_16x16x32_bf16 v[112:115], a[88:91], a[32:35], 0
    ds_read_b64_tr_b16 a[74:75], v120 offset:4672
    s_waitcnt vmcnt(6)
    buffer_load_dwordx4 a[20:23], v4, s[32:35], s84 offen offset:1024 sc1
    buffer_load_dwordx4 a[52:55], v4, s[32:35], s86 offen offset:1024 sc1
    s_waitcnt lgkmcnt(6)
    v_mfma_f32_16x16x32_bf16 v[60:63], a[96:99], a[4:7], v[60:63]
    ds_read_b64_tr_b16 a[80:81], v116 offset:8192
    v_mfma_f32_16x16x32_bf16 v[88:91], a[96:99], a[36:39], v[88:91]
    ds_read_b64_tr_b16 a[82:83], v116 offset:10240
    v_mfma_f32_16x16x32_bf16 v[64:67], a[100:103], a[4:7], v[64:67]
    ds_read_b64_tr_b16 a[84:85], v117 offset:8192
    v_mfma_f32_16x16x32_bf16 v[92:95], a[100:103], a[36:39], v[92:95]
    ds_read_b64_tr_b16 a[86:87], v117 offset:10240
    v_mfma_f32_16x16x32_bf16 v[68:71], a[104:107], a[4:7], v[68:71]
    ds_read_b64_tr_b16 a[88:89], v118 offset:8192
    v_mfma_f32_16x16x32_bf16 v[96:99], a[104:107], a[36:39], v[96:99]
    ds_read_b64_tr_b16 a[90:91], v118 offset:10240
    v_mfma_f32_16x16x32_bf16 v[72:75], a[108:111], a[4:7], v[72:75]
    ds_read_b64_tr_b16 a[92:93], v119 offset:8192
    v_mfma_f32_16x16x32_bf16 v[100:103], a[108:111], a[36:39], v[100:103]
    ds_read_b64_tr_b16 a[94:95], v119 offset:10240
    s_waitcnt lgkmcnt(8)
    v_mfma_f32_16x16x32_bf16 v[76:79], a[64:67], a[4:7], v[76:79]
    ds_read_b64_tr_b16 a[96:97], v120 offset:6144
    v_mfma_f32_16x16x32_bf16 v[104:107], a[64:67], a[36:39], v[104:107]
    ds_read_b64_tr_b16 a[98:99], v120 offset:7680
    v_mfma_f32_16x16x32_bf16 v[80:83], a[68:71], a[4:7], v[80:83]
    ds_read_b64_tr_b16 a[100:101], v120 offset:6176
    v_mfma_f32_16x16x32_bf16 v[108:111], a[68:71], a[36:39], v[108:111]
    ds_read_b64_tr_b16 a[102:103], v120 offset:7712
    v_mfma_f32_16x16x32_bf16 v[84:87], a[72:75], a[4:7], v[84:87]
    ds_read_b64_tr_b16 a[104:105], v120 offset:6208
    v_mfma_f32_16x16x32_bf16 v[112:115], a[72:75], a[36:39], v[112:115]
    ds_read_b64_tr_b16 a[106:107], v120 offset:7744
    s_waitcnt vmcnt(6)
    buffer_load_dwordx4 a[24:27], v4, s[32:35], s84 offen offset:2048 sc1
    buffer_load_dwordx4 a[56:59], v4, s[32:35], s86 offen offset:2048 sc1
    s_waitcnt lgkmcnt(6)
    v_mfma_f32_16x16x32_bf16 v[60:63], a[80:83], a[8:11], v[60:63]
    ds_read_b64_tr_b16 a[64:65], v116 offset:12288
    v_mfma_f32_16x16x32_bf16 v[88:91], a[80:83], a[40:43], v[88:91]
    ds_read_b64_tr_b16 a[66:67], v116 offset:14336
    v_mfma_f32_16x16x32_bf16 v[64:67], a[84:87], a[8:11], v[64:67]
    ds_read_b64_tr_b16 a[68:69], v117 offset:12288
    v_mfma_f32_16x16x32_bf16 v[92:95], a[84:87], a[40:43], v[92:95]
    ds_read_b64_tr_b16 a[70:71], v117 offset:14336
    v_mfma_f32_16x16x32_bf16 v[68:71], a[88:91], a[8:11], v[68:71]
    ds_read_b64_tr_b16 a[72:73], v118 offset:12288
    v_mfma_f32_16x16x32_bf16 v[96:99], a[88:91], a[40:43], v[96:99]
    ds_read_b64_tr_b16 a[74:75], v118 offset:14336
    v_mfma_f32_16x16x32_bf16 v[72:75], a[92:95], a[8:11], v[72:75]
    ds_read_b64_tr_b16 a[76:77], v119 offset:12288
    v_mfma_f32_16x16x32_bf16 v[100:103], a[92:95], a[40:43], v[100:103]
    ds_read_b64_tr_b16 a[78:79], v119 offset:14336
    s_waitcnt lgkmcnt(8)
    v_mfma_f32_16x16x32_bf16 v[76:79], a[96:99], a[8:11], v[76:79]
    ds_read_b64_tr_b16 a[80:81], v120 offset:9216
    v_mfma_f32_16x16x32_bf16 v[104:107], a[96:99], a[40:43], v[104:107]
    ds_read_b64_tr_b16 a[82:83], v120 offset:10752
    v_mfma_f32_16x16x32_bf16 v[80:83], a[100:103], a[8:11], v[80:83]
    ds_read_b64_tr_b16 a[84:85], v120 offset:9248
    v_mfma_f32_16x16x32_bf16 v[108:111], a[100:103], a[40:43], v[108:111]
    ds_read_b64_tr_b16 a[86:87], v120 offset:10784
    v_mfma_f32_16x16x32_bf16 v[84:87], a[104:107], a[8:11], v[84:87]
    ds_read_b64_tr_b16 a[88:89], v120 offset:9280
    v_mfma_f32_16x16x32_bf16 v[112:115], a[104:107], a[40:43], v[112:115]
    ds_read_b64_tr_b16 a[90:91], v120 offset:10816
    s_waitcnt vmcnt(6)
    buffer_load_dwordx4 a[28:31], v4, s[32:35], s84 offen offset:3072 sc1
    buffer_load_dwordx4 a[60:63], v4, s[32:35], s86 offen offset:3072 sc1
    s_waitcnt lgkmcnt(6)
    v_mfma_f32_16x16x32_bf16 v[60:63], a[64:67], a[12:15], v[60:63]
    ds_read_b64_tr_b16 a[96:97], v116 offset:16384
    v_mfma_f32_16x16x32_bf16 v[88:91], a[64:67], a[44:47], v[88:91]
    ds_read_b64_tr_b16 a[98:99], v116 offset:18432
    v_mfma_f32_16x16x32_bf16 v[64:67], a[68:71], a[12:15], v[64:67]
    ds_read_b64_tr_b16 a[100:101], v117 offset:16384
    v_mfma_f32_16x16x32_bf16 v[92:95], a[68:71], a[44:47], v[92:95]
    ds_read_b64_tr_b16 a[102:103], v117 offset:18432
    v_mfma_f32_16x16x32_bf16 v[68:71], a[72:75], a[12:15], v[68:71]
    ds_read_b64_tr_b16 a[104:105], v118 offset:16384
    v_mfma_f32_16x16x32_bf16 v[96:99], a[72:75], a[44:47], v[96:99]
    ds_read_b64_tr_b16 a[106:107], v118 offset:18432
    v_mfma_f32_16x16x32_bf16 v[72:75], a[76:79], a[12:15], v[72:75]
    ds_read_b64_tr_b16 a[108:109], v119 offset:16384
    v_mfma_f32_16x16x32_bf16 v[100:103], a[76:79], a[44:47], v[100:103]
    ds_read_b64_tr_b16 a[110:111], v119 offset:18432
    s_waitcnt lgkmcnt(8)
    v_mfma_f32_16x16x32_bf16 v[76:79], a[80:83], a[12:15], v[76:79]
    ds_read_b64_tr_b16 a[64:65], v120 offset:12288
    v_mfma_f32_16x16x32_bf16 v[104:107], a[80:83], a[44:47], v[104:107]
    ds_read_b64_tr_b16 a[66:67], v120 offset:13824
    v_mfma_f32_16x16x32_bf16 v[80:83], a[84:87], a[12:15], v[80:83]
    ds_read_b64_tr_b16 a[68:69], v120 offset:12320
    v_mfma_f32_16x16x32_bf16 v[108:111], a[84:87], a[44:47], v[108:111]
    ds_read_b64_tr_b16 a[70:71], v120 offset:13856
    v_mfma_f32_16x16x32_bf16 v[84:87], a[88:91], a[12:15], v[84:87]
    ds_read_b64_tr_b16 a[72:73], v120 offset:12352
    v_mfma_f32_16x16x32_bf16 v[112:115], a[88:91], a[44:47], v[112:115]
    ds_read_b64_tr_b16 a[74:75], v120 offset:13888
    s_waitcnt vmcnt(6)
    s_waitcnt lgkmcnt(6)
    v_mfma_f32_16x16x32_bf16 v[60:63], a[96:99], a[16:19], v[60:63]
    ds_read_b64_tr_b16 a[80:81], v116 offset:20480
    v_mfma_f32_16x16x32_bf16 v[88:91], a[96:99], a[48:51], v[88:91]
    ds_read_b64_tr_b16 a[82:83], v116 offset:22528
    v_mfma_f32_16x16x32_bf16 v[64:67], a[100:103], a[16:19], v[64:67]
    ds_read_b64_tr_b16 a[84:85], v117 offset:20480
    v_mfma_f32_16x16x32_bf16 v[92:95], a[100:103], a[48:51], v[92:95]
    ds_read_b64_tr_b16 a[86:87], v117 offset:22528
    v_mfma_f32_16x16x32_bf16 v[68:71], a[104:107], a[16:19], v[68:71]
    ds_read_b64_tr_b16 a[88:89], v118 offset:20480
    v_mfma_f32_16x16x32_bf16 v[96:99], a[104:107], a[48:51], v[96:99]
    ds_read_b64_tr_b16 a[90:91], v118 offset:22528
    v_mfma_f32_16x16x32_bf16 v[72:75], a[108:111], a[16:19], v[72:75]
    ds_read_b64_tr_b16 a[92:93], v119 offset:20480
    v_mfma_f32_16x16x32_bf16 v[100:103], a[108:111], a[48:51], v[100:103]
    ds_read_b64_tr_b16 a[94:95], v119 offset:22528
    s_mul_i32 s59, s48, 7168
    buffer_load_dword v13, v25, s[20:23], s59 offen
    s_waitcnt lgkmcnt(8)
    v_mfma_f32_16x16x32_bf16 v[76:79], a[64:67], a[16:19], v[76:79]
    ds_read_b64_tr_b16 a[96:97], v120 offset:15360
    v_mfma_f32_16x16x32_bf16 v[104:107], a[64:67], a[48:51], v[104:107]
    ds_read_b64_tr_b16 a[98:99], v120 offset:16896
    v_mfma_f32_16x16x32_bf16 v[80:83], a[68:71], a[16:19], v[80:83]
    ds_read_b64_tr_b16 a[100:101], v120 offset:15392
    v_mfma_f32_16x16x32_bf16 v[108:111], a[68:71], a[48:51], v[108:111]
    ds_read_b64_tr_b16 a[102:103], v120 offset:16928
    v_mfma_f32_16x16x32_bf16 v[84:87], a[72:75], a[16:19], v[84:87]
    ds_read_b64_tr_b16 a[104:105], v120 offset:15424
    v_mfma_f32_16x16x32_bf16 v[112:115], a[72:75], a[48:51], v[112:115]
    ds_read_b64_tr_b16 a[106:107], v120 offset:16960
    s_waitcnt vmcnt(5)
    s_waitcnt lgkmcnt(6)
    v_mfma_f32_16x16x32_bf16 v[60:63], a[80:83], a[20:23], v[60:63]
    ds_read_b64_tr_b16 a[64:65], v116 offset:24576
    v_mfma_f32_16x16x32_bf16 v[88:91], a[80:83], a[52:55], v[88:91]
    ds_read_b64_tr_b16 a[66:67], v116 offset:26624
    v_mfma_f32_16x16x32_bf16 v[64:67], a[84:87], a[20:23], v[64:67]
    ds_read_b64_tr_b16 a[68:69], v117 offset:24576
    v_mfma_f32_16x16x32_bf16 v[92:95], a[84:87], a[52:55], v[92:95]
    ds_read_b64_tr_b16 a[70:71], v117 offset:26624
    v_mfma_f32_16x16x32_bf16 v[68:71], a[88:91], a[20:23], v[68:71]
    ds_read_b64_tr_b16 a[72:73], v118 offset:24576
    v_mfma_f32_16x16x32_bf16 v[96:99], a[88:91], a[52:55], v[96:99]
    ds_read_b64_tr_b16 a[74:75], v118 offset:26624
    v_mfma_f32_16x16x32_bf16 v[72:75], a[92:95], a[20:23], v[72:75]
    ds_read_b64_tr_b16 a[76:77], v119 offset:24576
    v_mfma_f32_16x16x32_bf16 v[100:103], a[92:95], a[52:55], v[100:103]
    ds_read_b64_tr_b16 a[78:79], v119 offset:26624
    s_waitcnt lgkmcnt(8)
    v_mfma_f32_16x16x32_bf16 v[76:79], a[96:99], a[20:23], v[76:79]
    ds_read_b64_tr_b16 a[80:81], v120 offset:18432
    v_mfma_f32_16x16x32_bf16 v[104:107], a[96:99], a[52:55], v[104:107]
    ds_read_b64_tr_b16 a[82:83], v120 offset:19968
    v_mfma_f32_16x16x32_bf16 v[80:83], a[100:103], a[20:23], v[80:83]
    ds_read_b64_tr_b16 a[84:85], v120 offset:18464
    v_mfma_f32_16x16x32_bf16 v[108:111], a[100:103], a[52:55], v[108:111]
    ds_read_b64_tr_b16 a[86:87], v120 offset:20000
    v_mfma_f32_16x16x32_bf16 v[84:87], a[104:107], a[20:23], v[84:87]
    ds_read_b64_tr_b16 a[88:89], v120 offset:18496
    v_mfma_f32_16x16x32_bf16 v[112:115], a[104:107], a[52:55], v[112:115]
    ds_read_b64_tr_b16 a[90:91], v120 offset:20032
    s_waitcnt vmcnt(3)
    s_waitcnt lgkmcnt(6)
    v_mfma_f32_16x16x32_bf16 v[60:63], a[64:67], a[24:27], v[60:63]
    ds_read_b64_tr_b16 a[96:97], v116 offset:28672
    v_mfma_f32_16x16x32_bf16 v[88:91], a[64:67], a[56:59], v[88:91]
    ds_read_b64_tr_b16 a[98:99], v116 offset:30720
    v_mfma_f32_16x16x32_bf16 v[64:67], a[68:71], a[24:27], v[64:67]
    ds_read_b64_tr_b16 a[100:101], v117 offset:28672
    v_mfma_f32_16x16x32_bf16 v[92:95], a[68:71], a[56:59], v[92:95]
    ds_read_b64_tr_b16 a[102:103], v117 offset:30720
    v_mfma_f32_16x16x32_bf16 v[68:71], a[72:75], a[24:27], v[68:71]
    ds_read_b64_tr_b16 a[104:105], v118 offset:28672
    v_mfma_f32_16x16x32_bf16 v[96:99], a[72:75], a[56:59], v[96:99]
    ds_read_b64_tr_b16 a[106:107], v118 offset:30720
    v_mfma_f32_16x16x32_bf16 v[72:75], a[76:79], a[24:27], v[72:75]
    ds_read_b64_tr_b16 a[108:109], v119 offset:28672
    v_mfma_f32_16x16x32_bf16 v[100:103], a[76:79], a[56:59], v[100:103]
    ds_read_b64_tr_b16 a[110:111], v119 offset:30720
    s_waitcnt lgkmcnt(8)
    v_mfma_f32_16x16x32_bf16 v[76:79], a[80:83], a[24:27], v[76:79]
    ds_read_b64_tr_b16 a[64:65], v120 offset:21504
    v_mfma_f32_16x16x32_bf16 v[104:107], a[80:83], a[56:59], v[104:107]
    ds_read_b64_tr_b16 a[66:67], v120 offset:23040
    v_mfma_f32_16x16x32_bf16 v[80:83], a[84:87], a[24:27], v[80:83]
    ds_read_b64_tr_b16 a[68:69], v120 offset:21536
    v_mfma_f32_16x16x32_bf16 v[108:111], a[84:87], a[56:59], v[108:111]
    ds_read_b64_tr_b16 a[70:71], v120 offset:23072
    v_mfma_f32_16x16x32_bf16 v[84:87], a[88:91], a[24:27], v[84:87]
    ds_read_b64_tr_b16 a[72:73], v120 offset:21568
    v_mfma_f32_16x16x32_bf16 v[112:115], a[88:91], a[56:59], v[112:115]
    ds_read_b64_tr_b16 a[74:75], v120 offset:23104
    s_waitcnt vmcnt(1)
    s_waitcnt lgkmcnt(6)
    v_mfma_f32_16x16x32_bf16 v[60:63], a[96:99], a[28:31], v[60:63]
    v_mfma_f32_16x16x32_bf16 v[88:91], a[96:99], a[60:63], v[88:91]
    v_mfma_f32_16x16x32_bf16 v[64:67], a[100:103], a[28:31], v[64:67]
    v_mfma_f32_16x16x32_bf16 v[92:95], a[100:103], a[60:63], v[92:95]
    v_mfma_f32_16x16x32_bf16 v[68:71], a[104:107], a[28:31], v[68:71]
    v_mfma_f32_16x16x32_bf16 v[96:99], a[104:107], a[60:63], v[96:99]
    v_mfma_f32_16x16x32_bf16 v[72:75], a[108:111], a[28:31], v[72:75]
    v_mfma_f32_16x16x32_bf16 v[100:103], a[108:111], a[60:63], v[100:103]
    s_waitcnt lgkmcnt(0)
    v_mfma_f32_16x16x32_bf16 v[76:79], a[64:67], a[28:31], v[76:79]
    v_mfma_f32_16x16x32_bf16 v[104:107], a[64:67], a[60:63], v[104:107]
    v_mfma_f32_16x16x32_bf16 v[80:83], a[68:71], a[28:31], v[80:83]
    v_mfma_f32_16x16x32_bf16 v[108:111], a[68:71], a[60:63], v[108:111]
    v_mfma_f32_16x16x32_bf16 v[84:87], a[72:75], a[28:31], v[84:87]
    v_mfma_f32_16x16x32_bf16 v[112:115], a[72:75], a[60:63], v[112:115]
    s_barrier
    s_mul_i32 s39, s36, 7168
    s_add_u32 s39, s39, 65536
    v_add_u32 v116, s39, v4
    ds_write_b128 v116, v[88:91]
    ds_write_b128 v116, v[92:95] offset:1024
    ds_write_b128 v116, v[96:99] offset:2048
    ds_write_b128 v116, v[100:103] offset:3072
    ds_write_b128 v116, v[104:107] offset:4096
    ds_write_b128 v116, v[108:111] offset:5120
    ds_write_b128 v116, v[112:115] offset:6144
    s_xor_b32 s39, s36, 1
    s_mul_i32 s39, s39, 7168
    s_add_u32 s39, s39, 65536
    s_waitcnt lgkmcnt(0)
    s_barrier
    v_add_u32 v116, s39, v4
    ds_read_b128 v[88:91], v116
    ds_read_b128 v[92:95], v116 offset:1024
    ds_read_b128 v[96:99], v116 offset:2048
    ds_read_b128 v[100:103], v116 offset:3072
    ds_read_b128 v[104:107], v116 offset:4096
    ds_read_b128 v[108:111], v116 offset:5120
    ds_read_b128 v[112:115], v116 offset:6144
    s_waitcnt lgkmcnt(6)
    v_pk_add_f32 v[60:61], v[60:61], v[88:89]
    v_pk_add_f32 v[62:63], v[62:63], v[90:91]
    s_waitcnt lgkmcnt(5)
    v_pk_add_f32 v[64:65], v[64:65], v[92:93]
    v_pk_add_f32 v[66:67], v[66:67], v[94:95]
    s_waitcnt lgkmcnt(4)
    v_pk_add_f32 v[68:69], v[68:69], v[96:97]
    v_pk_add_f32 v[70:71], v[70:71], v[98:99]
    s_waitcnt lgkmcnt(3)
    v_pk_add_f32 v[72:73], v[72:73], v[100:101]
    v_pk_add_f32 v[74:75], v[74:75], v[102:103]
    s_waitcnt lgkmcnt(2)
    v_pk_add_f32 v[76:77], v[76:77], v[104:105]
    v_pk_add_f32 v[78:79], v[78:79], v[106:107]
    s_waitcnt lgkmcnt(1)
    v_pk_add_f32 v[80:81], v[80:81], v[108:109]
    v_pk_add_f32 v[82:83], v[82:83], v[110:111]
    s_waitcnt lgkmcnt(0)
    v_pk_add_f32 v[84:85], v[84:85], v[112:113]
    v_pk_add_f32 v[86:87], v[86:87], v[114:115]
    v_add_u32 v8, 147840, v15
    ds_read_b128 v[88:91], v8
    ds_read_b128 v[92:95], v8 offset:64
    ds_read_b128 v[96:99], v8 offset:128
    ds_read_b128 v[100:103], v8 offset:192
    ds_read_b128 v[104:107], v8 offset:256
    ds_read_b128 v[108:111], v8 offset:320
    ds_read_b128 v[112:115], v8 offset:384
    s_waitcnt lgkmcnt(0)
    v_pk_fma_f32 v[60:61], v[88:89], v[54:55], v[60:61] op_sel_hi:[1,0,1]
    v_pk_mul_f32 v[60:61], v[60:61], v[56:57] op_sel_hi:[1,0]
    v_cvt_pk_bf16_f32 v7, v60, v61
    v_lshlrev_b32 v60, 16, v7
    v_and_b32 v61, 4294901760, v7
    v_pk_mul_f32 v[26:27], v[60:61], s[52:53]
    v_exp_f32 v26, v26
    v_exp_f32 v27, v27
    s_nop 0
    v_pk_add_f32 v[26:27], v[26:27], s[56:57]
    v_rcp_f32 v26, v26
    v_rcp_f32 v27, v27
    s_nop 0
    v_pk_mul_f32 v[60:61], v[60:61], v[26:27]
    v_cvt_pk_bf16_f32 v120, v60, v61
    v_pk_fma_f32 v[62:63], v[90:91], v[54:55], v[62:63] op_sel_hi:[1,0,1]
    v_pk_mul_f32 v[62:63], v[62:63], v[56:57] op_sel_hi:[1,0]
    v_cvt_pk_bf16_f32 v7, v62, v63
    v_lshlrev_b32 v62, 16, v7
    v_and_b32 v63, 4294901760, v7
    v_pk_mul_f32 v[26:27], v[62:63], s[52:53]
    v_exp_f32 v26, v26
    v_exp_f32 v27, v27
    s_nop 0
    v_pk_add_f32 v[26:27], v[26:27], s[56:57]
    v_rcp_f32 v26, v26
    v_rcp_f32 v27, v27
    s_nop 0
    v_pk_mul_f32 v[62:63], v[62:63], v[26:27]
    v_cvt_pk_bf16_f32 v121, v62, v63
    v_pk_fma_f32 v[64:65], v[92:93], v[54:55], v[64:65] op_sel_hi:[1,0,1]
    v_pk_mul_f32 v[64:65], v[64:65], v[56:57] op_sel_hi:[1,0]
    v_cvt_pk_bf16_f32 v7, v64, v65
    v_lshlrev_b32 v64, 16, v7
    v_and_b32 v65, 4294901760, v7
    v_pk_mul_f32 v[26:27], v[64:65], s[52:53]
    v_exp_f32 v26, v26
    v_exp_f32 v27, v27
    s_nop 0
    v_pk_add_f32 v[26:27], v[26:27], s[56:57]
    v_rcp_f32 v26, v26
    v_rcp_f32 v27, v27
    s_nop 0
    v_pk_mul_f32 v[64:65], v[64:65], v[26:27]
    v_cvt_pk_bf16_f32 v122, v64, v65
    v_pk_fma_f32 v[66:67], v[94:95], v[54:55], v[66:67] op_sel_hi:[1,0,1]
    v_pk_mul_f32 v[66:67], v[66:67], v[56:57] op_sel_hi:[1,0]
    v_cvt_pk_bf16_f32 v7, v66, v67
    v_lshlrev_b32 v66, 16, v7
    v_and_b32 v67, 4294901760, v7
    v_pk_mul_f32 v[26:27], v[66:67], s[52:53]
    v_exp_f32 v26, v26
    v_exp_f32 v27, v27
    s_nop 0
    v_pk_add_f32 v[26:27], v[26:27], s[56:57]
    v_rcp_f32 v26, v26
    v_rcp_f32 v27, v27
    s_nop 0
    v_pk_mul_f32 v[66:67], v[66:67], v[26:27]
    v_cvt_pk_bf16_f32 v123, v66, v67
    buffer_store_dwordx4 v[120:123], v4, s[32:35], s87 offen sc1
    v_pk_fma_f32 v[68:69], v[96:97], v[54:55], v[68:69] op_sel_hi:[1,0,1]
    v_pk_mul_f32 v[68:69], v[68:69], v[56:57] op_sel_hi:[1,0]
    v_cvt_pk_bf16_f32 v7, v68, v69
    v_lshlrev_b32 v68, 16, v7
    v_and_b32 v69, 4294901760, v7
    v_pk_mul_f32 v[26:27], v[68:69], s[52:53]
    v_exp_f32 v26, v26
    v_exp_f32 v27, v27
    s_nop 0
    v_pk_add_f32 v[26:27], v[26:27], s[56:57]
    v_rcp_f32 v26, v26
    v_rcp_f32 v27, v27
    s_nop 0
    v_pk_mul_f32 v[68:69], v[68:69], v[26:27]
    v_cvt_pk_bf16_f32 v124, v68, v69
    v_pk_fma_f32 v[70:71], v[98:99], v[54:55], v[70:71] op_sel_hi:[1,0,1]
    v_pk_mul_f32 v[70:71], v[70:71], v[56:57] op_sel_hi:[1,0]
    v_cvt_pk_bf16_f32 v7, v70, v71
    v_lshlrev_b32 v70, 16, v7
    v_and_b32 v71, 4294901760, v7
    v_pk_mul_f32 v[26:27], v[70:71], s[52:53]
    v_exp_f32 v26, v26
    v_exp_f32 v27, v27
    s_nop 0
    v_pk_add_f32 v[26:27], v[26:27], s[56:57]
    v_rcp_f32 v26, v26
    v_rcp_f32 v27, v27
    s_nop 0
    v_pk_mul_f32 v[70:71], v[70:71], v[26:27]
    v_cvt_pk_bf16_f32 v125, v70, v71
    v_pk_fma_f32 v[72:73], v[100:101], v[54:55], v[72:73] op_sel_hi:[1,0,1]
    v_pk_mul_f32 v[72:73], v[72:73], v[56:57] op_sel_hi:[1,0]
    v_cvt_pk_bf16_f32 v7, v72, v73
    v_lshlrev_b32 v72, 16, v7
    v_and_b32 v73, 4294901760, v7
    v_pk_mul_f32 v[26:27], v[72:73], s[52:53]
    v_exp_f32 v26, v26
    v_exp_f32 v27, v27
    s_nop 0
    v_pk_add_f32 v[26:27], v[26:27], s[56:57]
    v_rcp_f32 v26, v26
    v_rcp_f32 v27, v27
    s_nop 0
    v_pk_mul_f32 v[72:73], v[72:73], v[26:27]
    v_cvt_pk_bf16_f32 v126, v72, v73
    v_pk_fma_f32 v[74:75], v[102:103], v[54:55], v[74:75] op_sel_hi:[1,0,1]
    v_pk_mul_f32 v[74:75], v[74:75], v[56:57] op_sel_hi:[1,0]
    v_cvt_pk_bf16_f32 v7, v74, v75
    v_lshlrev_b32 v74, 16, v7
    v_and_b32 v75, 4294901760, v7
    v_pk_mul_f32 v[26:27], v[74:75], s[52:53]
    v_exp_f32 v26, v26
    v_exp_f32 v27, v27
    s_nop 0
    v_pk_add_f32 v[26:27], v[26:27], s[56:57]
    v_rcp_f32 v26, v26
    v_rcp_f32 v27, v27
    s_nop 0
    v_pk_mul_f32 v[74:75], v[74:75], v[26:27]
    v_cvt_pk_bf16_f32 v127, v74, v75
    buffer_store_dwordx4 v[124:127], v4, s[32:35], s87 offen offset:1024 sc1
    v_pk_fma_f32 v[76:77], v[104:105], v[54:55], v[76:77] op_sel_hi:[1,0,1]
    v_pk_mul_f32 v[76:77], v[76:77], v[56:57] op_sel_hi:[1,0]
    v_cvt_pk_bf16_f32 v7, v76, v77
    v_lshlrev_b32 v76, 16, v7
    v_and_b32 v77, 4294901760, v7
    v_pk_mul_f32 v[26:27], v[76:77], s[52:53]
    v_exp_f32 v26, v26
    v_exp_f32 v27, v27
    s_add_u32 m0, s69, 0
    s_add_u32 s73, s71, 0
    buffer_load_dwordx4 v30, s[20:23], s73 offen lds
    v_pk_add_f32 v[26:27], v[26:27], s[56:57]
    v_rcp_f32 v26, v26
    v_rcp_f32 v27, v27
    s_nop 0
    v_pk_mul_f32 v[76:77], v[76:77], v[26:27]
    v_cvt_pk_bf16_f32 v120, v76, v77
    v_pk_fma_f32 v[78:79], v[106:107], v[54:55], v[78:79] op_sel_hi:[1,0,1]
    v_pk_mul_f32 v[78:79], v[78:79], v[56:57] op_sel_hi:[1,0]
    v_cvt_pk_bf16_f32 v7, v78, v79
    s_add_u32 m0, s69, 1024
    s_add_u32 s73, s71, 8192
    buffer_load_dwordx4 v30, s[20:23], s73 offen lds
    v_lshlrev_b32 v78, 16, v7
    v_and_b32 v79, 4294901760, v7
    v_pk_mul_f32 v[26:27], v[78:79], s[52:53]
    v_exp_f32 v26, v26
    v_exp_f32 v27, v27
    s_nop 0
    v_pk_add_f32 v[26:27], v[26:27], s[56:57]
    v_rcp_f32 v26, v26
    v_rcp_f32 v27, v27
    s_add_u32 m0, s69, 16384
    s_add_u32 s73, s71, 32768
    buffer_load_dwordx4 v30, s[20:23], s73 offen lds
    v_pk_mul_f32 v[78:79], v[78:79], v[26:27]
    v_cvt_pk_bf16_f32 v121, v78, v79
    s_waitcnt vmcnt(3)
    s_barrier
    buffer_atomic_add v9, v11, s[32:35], s44 offen sc1
    v_pk_fma_f32 v[80:81], v[108:109], v[54:55], v[80:81] op_sel_hi:[1,0,1]
    v_pk_mul_f32 v[80:81], v[80:81], v[56:57] op_sel_hi:[1,0]
    v_cvt_pk_bf16_f32 v7, v80, v81
    v_lshlrev_b32 v80, 16, v7
    v_and_b32 v81, 4294901760, v7
    v_pk_mul_f32 v[26:27], v[80:81], s[52:53]
    s_add_u32 m0, s69, 17408
    s_add_u32 s73, s71, 40960
    buffer_load_dwordx4 v30, s[20:23], s73 offen lds
    v_exp_f32 v26, v26
    v_exp_f32 v27, v27
    s_nop 0
    v_pk_add_f32 v[26:27], v[26:27], s[56:57]
    v_rcp_f32 v26, v26
    v_rcp_f32 v27, v27
    s_nop 0
    v_pk_mul_f32 v[80:81], v[80:81], v[26:27]
    v_cvt_pk_bf16_f32 v122, v80, v81
    v_pk_fma_f32 v[82:83], v[110:111], v[54:55], v[82:83] op_sel_hi:[1,0,1]
    s_add_u32 m0, s69, 32768
    s_add_u32 s73, s71, 114688
    buffer_load_dwordx4 v30, s[20:23], s73 offen lds
    v_pk_mul_f32 v[82:83], v[82:83], v[56:57] op_sel_hi:[1,0]
    v_cvt_pk_bf16_f32 v7, v82, v83
    v_lshlrev_b32 v82, 16, v7
    v_and_b32 v83, 4294901760, v7
    v_pk_mul_f32 v[26:27], v[82:83], s[52:53]
    v_exp_f32 v26, v26
    v_exp_f32 v27, v27
    s_nop 0
    v_pk_add_f32 v[26:27], v[26:27], s[56:57]
    s_add_u32 m0, s69, 33792
    s_add_u32 s73, s71, 122880
    buffer_load_dwordx4 v30, s[20:23], s73 offen lds
    v_rcp_f32 v26, v26
    v_rcp_f32 v27, v27
    s_nop 0
    v_pk_mul_f32 v[82:83], v[82:83], v[26:27]
    v_cvt_pk_bf16_f32 v123, v82, v83
    buffer_store_dwordx4 v[120:123], v4, s[32:35], s87 offen offset:2048 sc1
    v_pk_fma_f32 v[84:85], v[112:113], v[54:55], v[84:85] op_sel_hi:[1,0,1]
    v_pk_mul_f32 v[84:85], v[84:85], v[56:57] op_sel_hi:[1,0]
    v_cvt_pk_bf16_f32 v7, v84, v85
    v_lshlrev_b32 v84, 16, v7
    s_add_u32 m0, s69, 49152
    s_add_u32 s73, s71, 147456
    buffer_load_dwordx4 v30, s[20:23], s73 offen lds
    v_and_b32 v85, 4294901760, v7
    v_pk_mul_f32 v[26:27], v[84:85], s[52:53]
    v_exp_f32 v26, v26
    v_exp_f32 v27, v27
    s_nop 0
    v_pk_add_f32 v[26:27], v[26:27], s[56:57]
    v_rcp_f32 v26, v26
    v_rcp_f32 v27, v27
    s_nop 0
    v_pk_mul_f32 v[84:85], v[84:85], v[26:27]
    s_add_u32 m0, s69, 50176
    s_add_u32 s73, s71, 155648
    buffer_load_dwordx4 v30, s[20:23], s73 offen lds
    v_cvt_pk_bf16_f32 v124, v84, v85
    v_pk_fma_f32 v[86:87], v[114:115], v[54:55], v[86:87] op_sel_hi:[1,0,1]
    v_pk_mul_f32 v[86:87], v[86:87], v[56:57] op_sel_hi:[1,0]
    v_cvt_pk_bf16_f32 v7, v86, v87
    v_lshlrev_b32 v86, 16, v7
    v_and_b32 v87, 4294901760, v7
    v_pk_mul_f32 v[26:27], v[86:87], s[52:53]
    v_exp_f32 v26, v26
    v_exp_f32 v27, v27
    s_nop 0
    v_pk_add_f32 v[26:27], v[26:27], s[56:57]
    v_rcp_f32 v26, v26
    v_rcp_f32 v27, v27
    s_nop 0
    v_pk_mul_f32 v[86:87], v[86:87], v[26:27]
    v_cvt_pk_bf16_f32 v125, v86, v87
    buffer_store_dwordx2 v[124:125], v4, s[32:35], s88 offen sc1
    s_mul_i32 s82, s63, 56
    s_mul_i32 s40, s70, 14
    s_add_u32 s82, s82, s40
    s_lshl_b32 s82, s82, 10
    s_add_u32 s82, s82, 0xa00000
    s_xor_b32 s39, s63, 1
    s_mul_i32 s83, s39, 56
    s_mul_i32 s40, s70, 14
    s_add_u32 s83, s83, s40
    s_lshl_b32 s83, s83, 10
    s_add_u32 s83, s83, 0xa00000
    s_mov_b32 s60, 0
    s_cmp_lg_u32 s36, 0
    s_nop 3
    s_cbranch_scc1 Linterleave_layers__linear_attn_block__dense_activation_silu__prompt_kernel_21
Linterleave_layers__linear_attn_block__dense_activation_silu__prompt_kernel_20:
    buffer_load_dword v13, v10, s[32:35], s44 offen sc1
    s_waitcnt vmcnt(0)
    v_readfirstlane_b32 s39, v13
    s_nop 4
    s_cmp_ge_u32 s39, 48
    s_cbranch_scc1 Linterleave_layers__linear_attn_block__dense_activation_silu__prompt_kernel_21
    s_sleep 2
    s_add_u32 s60, s60, 1
    s_cmp_lt_u32 s60, 0x40000
    s_cbranch_scc1 Linterleave_layers__linear_attn_block__dense_activation_silu__prompt_kernel_20
Linterleave_layers__linear_attn_block__dense_activation_silu__prompt_kernel_21:
    s_nop 3
    s_waitcnt vmcnt(1)
    s_barrier
    s_add_u32 s59, s82, 0
    buffer_load_dwordx4 a[0:3], v4, s[32:35], s59 offen sc1
    s_add_u32 s59, s83, 0
    buffer_load_dwordx4 a[56:59], v4, s[32:35], s59 offen sc1
    s_add_u32 s59, s82, 1024
    buffer_load_dwordx4 a[4:7], v4, s[32:35], s59 offen sc1
    s_add_u32 s59, s83, 1024
    buffer_load_dwordx4 a[60:63], v4, s[32:35], s59 offen sc1
    s_add_u32 s59, s82, 3072
    buffer_load_dwordx4 a[8:11], v4, s[32:35], s59 offen sc1
    s_add_u32 s59, s83, 3072
    buffer_load_dwordx4 a[64:67], v4, s[32:35], s59 offen sc1
    s_lshl_b32 s84, s63, 4
    s_add_u32 s84, s84, s65
    s_lshl_b32 s84, s84, 10
    s_add_u32 s84, s84, 0x400000
    buffer_load_dwordx4 v[56:59], v4, s[32:35], s84 offen sc1
    s_lshl_b32 s39, s70, 12
    v_add_u32 v124, s39, v39
    v_add_u32 v128, 65536, v124
    v_add_u32 v132, 131072, v124
    v_add_u32 v125, s39, v40
    v_add_u32 v129, 65536, v125
    v_add_u32 v133, 131072, v125
    v_add_u32 v126, s39, v41
    v_add_u32 v130, 65536, v126
    v_add_u32 v134, 131072, v126
    v_add_u32 v127, s39, v42
    v_add_u32 v131, 65536, v127
    v_add_u32 v135, 131072, v127
    s_add_u32 m0, s69, 81920
    s_add_u32 s73, s71, 229376
    buffer_load_dwordx4 v30, s[20:23], s73 offen lds
    s_add_u32 m0, s69, 82944
    s_add_u32 s73, s71, 237568
    buffer_load_dwordx4 v30, s[20:23], s73 offen lds
    s_add_u32 m0, s69, 98304
    s_add_u32 s73, s71, 262144
    buffer_load_dwordx4 v30, s[20:23], s73 offen lds
    s_add_u32 m0, s69, 99328
    s_add_u32 s73, s71, 270336
    buffer_load_dwordx4 v30, s[20:23], s73 offen lds
    ds_read_b64_tr_b16 v[92:93], v124
    ds_read_b64_tr_b16 v[94:95], v124 offset:2048
    ds_read_b64_tr_b16 v[96:97], v125
    ds_read_b64_tr_b16 v[98:99], v125 offset:2048
    ds_read_b64_tr_b16 v[100:101], v126
    ds_read_b64_tr_b16 v[102:103], v126 offset:2048
    ds_read_b64_tr_b16 v[104:105], v127
    ds_read_b64_tr_b16 v[106:107], v127 offset:2048
    s_waitcnt vmcnt(9)
    s_add_u32 s59, s82, 4096
    buffer_load_dwordx4 a[12:15], v4, s[32:35], s59 offen sc1
    s_add_u32 s59, s83, 4096
    buffer_load_dwordx4 a[68:71], v4, s[32:35], s59 offen sc1
    s_waitcnt lgkmcnt(0)
    v_mfma_f32_16x16x32_bf16 v[60:63], v[92:95], a[0:3], 0
    ds_read_b64_tr_b16 v[108:109], v124 offset:16384
    v_mfma_f32_16x16x32_bf16 v[76:79], v[92:95], a[56:59], 0
    ds_read_b64_tr_b16 v[110:111], v124 offset:18432
    v_mfma_f32_16x16x32_bf16 v[64:67], v[96:99], a[0:3], 0
    ds_read_b64_tr_b16 v[112:113], v125 offset:16384
    v_mfma_f32_16x16x32_bf16 v[80:83], v[96:99], a[56:59], 0
    ds_read_b64_tr_b16 v[114:115], v125 offset:18432
    v_mfma_f32_16x16x32_bf16 v[68:71], v[100:103], a[0:3], 0
    ds_read_b64_tr_b16 v[116:117], v126 offset:16384
    v_mfma_f32_16x16x32_bf16 v[84:87], v[100:103], a[56:59], 0
    ds_read_b64_tr_b16 v[118:119], v126 offset:18432
    v_mfma_f32_16x16x32_bf16 v[72:75], v[104:107], a[0:3], 0
    ds_read_b64_tr_b16 v[120:121], v127 offset:16384
    v_mfma_f32_16x16x32_bf16 v[88:91], v[104:107], a[56:59], 0
    ds_read_b64_tr_b16 v[122:123], v127 offset:18432
    s_add_u32 m0, s69, 114688
    s_add_u32 s73, s71, 344064
    buffer_load_dwordx4 v30, s[20:23], s73 offen lds
    s_add_u32 m0, s69, 115712
    s_add_u32 s73, s71, 352256
    buffer_load_dwordx4 v30, s[20:23], s73 offen lds
    s_barrier
    buffer_atomic_add v9, v11, s[32:35], s44 offen sc1
    s_waitcnt vmcnt(12)
    s_add_u32 s59, s82, 7168
    buffer_load_dwordx4 a[16:19], v4, s[32:35], s59 offen sc1
    s_add_u32 s59, s83, 7168
    buffer_load_dwordx4 a[72:75], v4, s[32:35], s59 offen sc1
    s_waitcnt lgkmcnt(0)
    v_mfma_f32_16x16x32_bf16 v[60:63], v[108:111], a[4:7], v[60:63]
    ds_read_b64_tr_b16 v[92:93], v124 offset:32768
    v_mfma_f32_16x16x32_bf16 v[76:79], v[108:111], a[60:63], v[76:79]
    ds_read_b64_tr_b16 v[94:95], v124 offset:34816
    v_mfma_f32_16x16x32_bf16 v[64:67], v[112:115], a[4:7], v[64:67]
    ds_read_b64_tr_b16 v[96:97], v125 offset:32768
    v_mfma_f32_16x16x32_bf16 v[80:83], v[112:115], a[60:63], v[80:83]
    ds_read_b64_tr_b16 v[98:99], v125 offset:34816
    v_mfma_f32_16x16x32_bf16 v[68:71], v[116:119], a[4:7], v[68:71]
    ds_read_b64_tr_b16 v[100:101], v126 offset:32768
    v_mfma_f32_16x16x32_bf16 v[84:87], v[116:119], a[60:63], v[84:87]
    ds_read_b64_tr_b16 v[102:103], v126 offset:34816
    v_mfma_f32_16x16x32_bf16 v[72:75], v[120:123], a[4:7], v[72:75]
    ds_read_b64_tr_b16 v[104:105], v127 offset:32768
    v_mfma_f32_16x16x32_bf16 v[88:91], v[120:123], a[60:63], v[88:91]
    ds_read_b64_tr_b16 v[106:107], v127 offset:34816
    s_add_u32 m0, s69, 131072
    s_add_u32 s73, s71, 376832
    buffer_load_dwordx4 v30, s[20:23], s73 offen lds
    s_add_u32 m0, s69, 132096
    s_add_u32 s73, s71, 385024
    buffer_load_dwordx4 v30, s[20:23], s73 offen lds
    s_waitcnt vmcnt(14)
    s_add_u32 s59, s82, 8192
    buffer_load_dwordx4 a[20:23], v4, s[32:35], s59 offen sc1
    s_add_u32 s59, s83, 8192
    buffer_load_dwordx4 a[76:79], v4, s[32:35], s59 offen sc1
    s_waitcnt lgkmcnt(0)
    v_mfma_f32_16x16x32_bf16 v[60:63], v[92:95], a[8:11], v[60:63]
    ds_read_b64_tr_b16 v[108:109], v124 offset:49152
    v_mfma_f32_16x16x32_bf16 v[76:79], v[92:95], a[64:67], v[76:79]
    ds_read_b64_tr_b16 v[110:111], v124 offset:51200
    v_mfma_f32_16x16x32_bf16 v[64:67], v[96:99], a[8:11], v[64:67]
    ds_read_b64_tr_b16 v[112:113], v125 offset:49152
    v_mfma_f32_16x16x32_bf16 v[80:83], v[96:99], a[64:67], v[80:83]
    ds_read_b64_tr_b16 v[114:115], v125 offset:51200
    v_mfma_f32_16x16x32_bf16 v[68:71], v[100:103], a[8:11], v[68:71]
    ds_read_b64_tr_b16 v[116:117], v126 offset:49152
    v_mfma_f32_16x16x32_bf16 v[84:87], v[100:103], a[64:67], v[84:87]
    ds_read_b64_tr_b16 v[118:119], v126 offset:51200
    v_mfma_f32_16x16x32_bf16 v[72:75], v[104:107], a[8:11], v[72:75]
    ds_read_b64_tr_b16 v[120:121], v127 offset:49152
    v_mfma_f32_16x16x32_bf16 v[88:91], v[104:107], a[64:67], v[88:91]
    ds_read_b64_tr_b16 v[122:123], v127 offset:51200
    s_add_u32 m0, s69, 65536
    s_add_u32 s73, s71, 65536
    buffer_load_dwordx4 v30, s[20:23], s73 offen lds
    s_add_u32 m0, s69, 66560
    s_add_u32 s73, s71, 73728
    buffer_load_dwordx4 v30, s[20:23], s73 offen lds
    s_waitcnt vmcnt(13)
    s_barrier
    s_waitcnt vmcnt(11)
    s_add_u32 s59, s82, 10240
    buffer_load_dwordx4 a[24:27], v4, s[32:35], s59 offen sc1
    s_add_u32 s59, s83, 10240
    buffer_load_dwordx4 a[80:83], v4, s[32:35], s59 offen sc1
    s_waitcnt lgkmcnt(0)
    v_mfma_f32_16x16x32_bf16 v[60:63], v[108:111], a[12:15], v[60:63]
    ds_read_b64_tr_b16 v[92:93], v128 offset:16384
    v_mfma_f32_16x16x32_bf16 v[76:79], v[108:111], a[68:71], v[76:79]
    ds_read_b64_tr_b16 v[94:95], v128 offset:18432
    v_mfma_f32_16x16x32_bf16 v[64:67], v[112:115], a[12:15], v[64:67]
    ds_read_b64_tr_b16 v[96:97], v129 offset:16384
    v_mfma_f32_16x16x32_bf16 v[80:83], v[112:115], a[68:71], v[80:83]
    ds_read_b64_tr_b16 v[98:99], v129 offset:18432
    v_mfma_f32_16x16x32_bf16 v[68:71], v[116:119], a[12:15], v[68:71]
    ds_read_b64_tr_b16 v[100:101], v130 offset:16384
    v_mfma_f32_16x16x32_bf16 v[84:87], v[116:119], a[68:71], v[84:87]
    ds_read_b64_tr_b16 v[102:103], v130 offset:18432
    v_mfma_f32_16x16x32_bf16 v[72:75], v[120:123], a[12:15], v[72:75]
    ds_read_b64_tr_b16 v[104:105], v131 offset:16384
    v_mfma_f32_16x16x32_bf16 v[88:91], v[120:123], a[68:71], v[88:91]
    ds_read_b64_tr_b16 v[106:107], v131 offset:18432
    s_barrier
    s_waitcnt vmcnt(8)
    s_add_u32 s59, s82, 11264
    buffer_load_dwordx4 a[28:31], v4, s[32:35], s59 offen sc1
    s_add_u32 s59, s83, 11264
    buffer_load_dwordx4 a[84:87], v4, s[32:35], s59 offen sc1
    s_waitcnt lgkmcnt(0)
    v_mfma_f32_16x16x32_bf16 v[60:63], v[92:95], a[16:19], v[60:63]
    ds_read_b64_tr_b16 v[108:109], v128 offset:32768
    v_mfma_f32_16x16x32_bf16 v[76:79], v[92:95], a[72:75], v[76:79]
    ds_read_b64_tr_b16 v[110:111], v128 offset:34816
    v_mfma_f32_16x16x32_bf16 v[64:67], v[96:99], a[16:19], v[64:67]
    ds_read_b64_tr_b16 v[112:113], v129 offset:32768
    v_mfma_f32_16x16x32_bf16 v[80:83], v[96:99], a[72:75], v[80:83]
    ds_read_b64_tr_b16 v[114:115], v129 offset:34816
    v_mfma_f32_16x16x32_bf16 v[68:71], v[100:103], a[16:19], v[68:71]
    ds_read_b64_tr_b16 v[116:117], v130 offset:32768
    v_mfma_f32_16x16x32_bf16 v[84:87], v[100:103], a[72:75], v[84:87]
    ds_read_b64_tr_b16 v[118:119], v130 offset:34816
    v_mfma_f32_16x16x32_bf16 v[72:75], v[104:107], a[16:19], v[72:75]
    ds_read_b64_tr_b16 v[120:121], v131 offset:32768
    v_mfma_f32_16x16x32_bf16 v[88:91], v[104:107], a[72:75], v[88:91]
    ds_read_b64_tr_b16 v[122:123], v131 offset:34816
    s_add_u32 m0, s69, 0
    s_add_u32 s73, s71, 180224
    buffer_load_dwordx4 v30, s[20:23], s73 offen lds
    s_add_u32 m0, s69, 1024
    s_add_u32 s73, s71, 188416
    buffer_load_dwordx4 v30, s[20:23], s73 offen lds
    s_waitcnt vmcnt(6)
    s_barrier
    s_mov_b32 s60, 0
    s_cmp_lg_u32 s36, 0
    s_nop 3
    s_cbranch_scc1 Linterleave_layers__linear_attn_block__dense_activation_silu__prompt_kernel_23
Linterleave_layers__linear_attn_block__dense_activation_silu__prompt_kernel_22:
    buffer_load_dword v13, v10, s[32:35], s44 offen sc1
    s_waitcnt vmcnt(0)
    v_readfirstlane_b32 s39, v13
    s_nop 4
    s_cmp_ge_u32 s39, 64
    s_cbranch_scc1 Linterleave_layers__linear_attn_block__dense_activation_silu__prompt_kernel_23
    s_sleep 2
    s_add_u32 s60, s60, 1
    s_cmp_lt_u32 s60, 0x40000
    s_cbranch_scc1 Linterleave_layers__linear_attn_block__dense_activation_silu__prompt_kernel_22
Linterleave_layers__linear_attn_block__dense_activation_silu__prompt_kernel_23:
    s_nop 3
    s_barrier
    s_add_u32 s59, s82, 2048
    buffer_load_dwordx4 a[32:35], v4, s[32:35], s59 offen sc1
    s_add_u32 s59, s83, 2048
    buffer_load_dwordx4 a[88:91], v4, s[32:35], s59 offen sc1
    s_waitcnt lgkmcnt(0)
    v_mfma_f32_16x16x32_bf16 v[60:63], v[108:111], a[20:23], v[60:63]
    ds_read_b64_tr_b16 v[92:93], v128 offset:49152
    v_mfma_f32_16x16x32_bf16 v[76:79], v[108:111], a[76:79], v[76:79]
    ds_read_b64_tr_b16 v[94:95], v128 offset:51200
    v_mfma_f32_16x16x32_bf16 v[64:67], v[112:115], a[20:23], v[64:67]
    ds_read_b64_tr_b16 v[96:97], v129 offset:49152
    v_mfma_f32_16x16x32_bf16 v[80:83], v[112:115], a[76:79], v[80:83]
    ds_read_b64_tr_b16 v[98:99], v129 offset:51200
    v_mfma_f32_16x16x32_bf16 v[68:71], v[116:119], a[20:23], v[68:71]
    ds_read_b64_tr_b16 v[100:101], v130 offset:49152
    v_mfma_f32_16x16x32_bf16 v[84:87], v[116:119], a[76:79], v[84:87]
    ds_read_b64_tr_b16 v[102:103], v130 offset:51200
    v_mfma_f32_16x16x32_bf16 v[72:75], v[120:123], a[20:23], v[72:75]
    ds_read_b64_tr_b16 v[104:105], v131 offset:49152
    v_mfma_f32_16x16x32_bf16 v[88:91], v[120:123], a[76:79], v[88:91]
    ds_read_b64_tr_b16 v[106:107], v131 offset:51200
    s_add_u32 m0, s69, 16384
    s_add_u32 s73, s72, 98304
    buffer_load_dwordx4 v30, s[20:23], s73 offen lds
    s_add_u32 m0, s69, 17408
    s_add_u32 s73, s72, 106496
    buffer_load_dwordx4 v30, s[20:23], s73 offen lds
    s_waitcnt vmcnt(8)
    s_add_u32 s59, s82, 5120
    buffer_load_dwordx4 a[36:39], v4, s[32:35], s59 offen sc1
    s_add_u32 s59, s83, 5120
    buffer_load_dwordx4 a[92:95], v4, s[32:35], s59 offen sc1
    s_waitcnt lgkmcnt(0)
    v_mfma_f32_16x16x32_bf16 v[60:63], v[92:95], a[24:27], v[60:63]
    ds_read_b64_tr_b16 v[108:109], v132
    v_mfma_f32_16x16x32_bf16 v[76:79], v[92:95], a[80:83], v[76:79]
    ds_read_b64_tr_b16 v[110:111], v132 offset:2048
    v_mfma_f32_16x16x32_bf16 v[64:67], v[96:99], a[24:27], v[64:67]
    ds_read_b64_tr_b16 v[112:113], v133
    v_mfma_f32_16x16x32_bf16 v[80:83], v[96:99], a[80:83], v[80:83]
    ds_read_b64_tr_b16 v[114:115], v133 offset:2048
    v_mfma_f32_16x16x32_bf16 v[68:71], v[100:103], a[24:27], v[68:71]
    ds_read_b64_tr_b16 v[116:117], v134
    v_mfma_f32_16x16x32_bf16 v[84:87], v[100:103], a[80:83], v[84:87]
    ds_read_b64_tr_b16 v[118:119], v134 offset:2048
    v_mfma_f32_16x16x32_bf16 v[72:75], v[104:107], a[24:27], v[72:75]
    ds_read_b64_tr_b16 v[120:121], v135
    v_mfma_f32_16x16x32_bf16 v[88:91], v[104:107], a[80:83], v[88:91]
    ds_read_b64_tr_b16 v[122:123], v135 offset:2048
    s_add_u32 m0, s69, 32768
    s_add_u32 s73, s71, 294912
    buffer_load_dwordx4 v30, s[20:23], s73 offen lds
    s_add_u32 m0, s69, 33792
    s_add_u32 s73, s71, 303104
    buffer_load_dwordx4 v30, s[20:23], s73 offen lds
    s_waitcnt vmcnt(10)
    s_add_u32 s59, s82, 6144
    buffer_load_dwordx4 a[40:43], v4, s[32:35], s59 offen sc1
    s_add_u32 s59, s83, 6144
    buffer_load_dwordx4 a[96:99], v4, s[32:35], s59 offen sc1
    s_waitcnt lgkmcnt(0)
    v_mfma_f32_16x16x32_bf16 v[60:63], v[108:111], a[28:31], v[60:63]
    ds_read_b64_tr_b16 v[92:93], v128
    v_mfma_f32_16x16x32_bf16 v[76:79], v[108:111], a[84:87], v[76:79]
    ds_read_b64_tr_b16 v[94:95], v128 offset:2048
    v_mfma_f32_16x16x32_bf16 v[64:67], v[112:115], a[28:31], v[64:67]
    ds_read_b64_tr_b16 v[96:97], v129
    v_mfma_f32_16x16x32_bf16 v[80:83], v[112:115], a[84:87], v[80:83]
    ds_read_b64_tr_b16 v[98:99], v129 offset:2048
    v_mfma_f32_16x16x32_bf16 v[68:71], v[116:119], a[28:31], v[68:71]
    ds_read_b64_tr_b16 v[100:101], v130
    v_mfma_f32_16x16x32_bf16 v[84:87], v[116:119], a[84:87], v[84:87]
    ds_read_b64_tr_b16 v[102:103], v130 offset:2048
    v_mfma_f32_16x16x32_bf16 v[72:75], v[120:123], a[28:31], v[72:75]
    ds_read_b64_tr_b16 v[104:105], v131
    v_mfma_f32_16x16x32_bf16 v[88:91], v[120:123], a[84:87], v[88:91]
    ds_read_b64_tr_b16 v[106:107], v131 offset:2048
    s_add_u32 m0, s69, 49152
    s_add_u32 s73, s71, 409600
    buffer_load_dwordx4 v30, s[20:23], s73 offen lds
    s_add_u32 m0, s69, 50176
    s_add_u32 s73, s71, 417792
    buffer_load_dwordx4 v30, s[20:23], s73 offen lds
    s_waitcnt vmcnt(8)
    s_barrier
    s_add_u32 s59, s82, 9216
    buffer_load_dwordx4 a[44:47], v4, s[32:35], s59 offen sc1
    s_add_u32 s59, s83, 9216
    buffer_load_dwordx4 a[100:103], v4, s[32:35], s59 offen sc1
    s_waitcnt lgkmcnt(0)
    v_mfma_f32_16x16x32_bf16 v[60:63], v[92:95], a[32:35], v[60:63]
    ds_read_b64_tr_b16 v[108:109], v124
    v_mfma_f32_16x16x32_bf16 v[76:79], v[92:95], a[88:91], v[76:79]
    ds_read_b64_tr_b16 v[110:111], v124 offset:2048
    v_mfma_f32_16x16x32_bf16 v[64:67], v[96:99], a[32:35], v[64:67]
    ds_read_b64_tr_b16 v[112:113], v125
    v_mfma_f32_16x16x32_bf16 v[80:83], v[96:99], a[88:91], v[80:83]
    ds_read_b64_tr_b16 v[114:115], v125 offset:2048
    v_mfma_f32_16x16x32_bf16 v[68:71], v[100:103], a[32:35], v[68:71]
    ds_read_b64_tr_b16 v[116:117], v126
    v_mfma_f32_16x16x32_bf16 v[84:87], v[100:103], a[88:91], v[84:87]
    ds_read_b64_tr_b16 v[118:119], v126 offset:2048
    v_mfma_f32_16x16x32_bf16 v[72:75], v[104:107], a[32:35], v[72:75]
    ds_read_b64_tr_b16 v[120:121], v127
    v_mfma_f32_16x16x32_bf16 v[88:91], v[104:107], a[88:91], v[88:91]
    ds_read_b64_tr_b16 v[122:123], v127 offset:2048
    s_barrier
    s_waitcnt vmcnt(8)
    s_add_u32 s59, s82, 12288
    buffer_load_dwordx4 a[48:51], v4, s[32:35], s59 offen sc1
    s_add_u32 s59, s83, 12288
    buffer_load_dwordx4 a[104:107], v4, s[32:35], s59 offen sc1
    s_waitcnt lgkmcnt(0)
    v_mfma_f32_16x16x32_bf16 v[60:63], v[108:111], a[36:39], v[60:63]
    ds_read_b64_tr_b16 v[92:93], v124 offset:16384
    v_mfma_f32_16x16x32_bf16 v[76:79], v[108:111], a[92:95], v[76:79]
    ds_read_b64_tr_b16 v[94:95], v124 offset:18432
    v_mfma_f32_16x16x32_bf16 v[64:67], v[112:115], a[36:39], v[64:67]
    ds_read_b64_tr_b16 v[96:97], v125 offset:16384
    v_mfma_f32_16x16x32_bf16 v[80:83], v[112:115], a[92:95], v[80:83]
    ds_read_b64_tr_b16 v[98:99], v125 offset:18432
    v_mfma_f32_16x16x32_bf16 v[68:71], v[116:119], a[36:39], v[68:71]
    ds_read_b64_tr_b16 v[100:101], v126 offset:16384
    v_mfma_f32_16x16x32_bf16 v[84:87], v[116:119], a[92:95], v[84:87]
    ds_read_b64_tr_b16 v[102:103], v126 offset:18432
    v_mfma_f32_16x16x32_bf16 v[72:75], v[120:123], a[36:39], v[72:75]
    ds_read_b64_tr_b16 v[104:105], v127 offset:16384
    v_mfma_f32_16x16x32_bf16 v[88:91], v[120:123], a[92:95], v[88:91]
    ds_read_b64_tr_b16 v[106:107], v127 offset:18432
    s_add_u32 m0, s69, 65536
    s_add_u32 s73, s72, 327680
    buffer_load_dwordx4 v30, s[20:23], s73 offen lds
    s_add_u32 m0, s69, 66560
    s_add_u32 s73, s72, 335872
    buffer_load_dwordx4 v30, s[20:23], s73 offen lds
    s_add_u32 m0, s58, 81920
    s_add_u32 s73, s74, 0
    buffer_load_dwordx4 v28, s[8:11], s73 offen lds
    s_add_u32 m0, s58, 90112
    s_add_u32 s73, s74, 196608
    buffer_load_dwordx4 v28, s[8:11], s73 offen lds
    s_waitcnt vmcnt(8)
    s_barrier
    s_add_u32 s59, s82, 13312
    buffer_load_dwordx4 a[52:55], v4, s[32:35], s59 offen sc1
    s_add_u32 s59, s83, 13312
    buffer_load_dwordx4 a[108:111], v4, s[32:35], s59 offen sc1
    s_waitcnt lgkmcnt(0)
    v_mfma_f32_16x16x32_bf16 v[60:63], v[92:95], a[40:43], v[60:63]
    ds_read_b64_tr_b16 v[108:109], v124 offset:32768
    v_mfma_f32_16x16x32_bf16 v[76:79], v[92:95], a[96:99], v[76:79]
    ds_read_b64_tr_b16 v[110:111], v124 offset:34816
    v_mfma_f32_16x16x32_bf16 v[64:67], v[96:99], a[40:43], v[64:67]
    ds_read_b64_tr_b16 v[112:113], v125 offset:32768
    v_mfma_f32_16x16x32_bf16 v[80:83], v[96:99], a[96:99], v[80:83]
    ds_read_b64_tr_b16 v[114:115], v125 offset:34816
    v_mfma_f32_16x16x32_bf16 v[68:71], v[100:103], a[40:43], v[68:71]
    ds_read_b64_tr_b16 v[116:117], v126 offset:32768
    v_mfma_f32_16x16x32_bf16 v[84:87], v[100:103], a[96:99], v[84:87]
    ds_read_b64_tr_b16 v[118:119], v126 offset:34816
    v_mfma_f32_16x16x32_bf16 v[72:75], v[104:107], a[40:43], v[72:75]
    ds_read_b64_tr_b16 v[120:121], v127 offset:32768
    v_mfma_f32_16x16x32_bf16 v[88:91], v[104:107], a[96:99], v[88:91]
    ds_read_b64_tr_b16 v[122:123], v127 offset:34816
    s_add_u32 m0, s58, 98304
    s_add_u32 s73, s74, 393216
    buffer_load_dwordx4 v28, s[8:11], s73 offen lds
    s_add_u32 m0, s58, 106496
    s_add_u32 s73, s74, 589824
    buffer_load_dwordx4 v28, s[8:11], s73 offen lds
    s_waitcnt vmcnt(10)
    s_waitcnt lgkmcnt(0)
    v_mfma_f32_16x16x32_bf16 v[60:63], v[108:111], a[44:47], v[60:63]
    ds_read_b64_tr_b16 v[92:93], v124 offset:49152
    v_mfma_f32_16x16x32_bf16 v[76:79], v[108:111], a[100:103], v[76:79]
    ds_read_b64_tr_b16 v[94:95], v124 offset:51200
    v_mfma_f32_16x16x32_bf16 v[64:67], v[112:115], a[44:47], v[64:67]
    ds_read_b64_tr_b16 v[96:97], v125 offset:49152
    v_mfma_f32_16x16x32_bf16 v[80:83], v[112:115], a[100:103], v[80:83]
    ds_read_b64_tr_b16 v[98:99], v125 offset:51200
    v_mfma_f32_16x16x32_bf16 v[68:71], v[116:119], a[44:47], v[68:71]
    ds_read_b64_tr_b16 v[100:101], v126 offset:49152
    v_mfma_f32_16x16x32_bf16 v[84:87], v[116:119], a[100:103], v[84:87]
    ds_read_b64_tr_b16 v[102:103], v126 offset:51200
    v_mfma_f32_16x16x32_bf16 v[72:75], v[120:123], a[44:47], v[72:75]
    ds_read_b64_tr_b16 v[104:105], v127 offset:49152
    v_mfma_f32_16x16x32_bf16 v[88:91], v[120:123], a[100:103], v[88:91]
    ds_read_b64_tr_b16 v[106:107], v127 offset:51200
    s_add_u32 m0, s58, 114688
    s_add_u32 s73, s74, 786432
    buffer_load_dwordx4 v28, s[8:11], s73 offen lds
    s_add_u32 m0, s58, 122880
    s_add_u32 s73, s74, 983040
    buffer_load_dwordx4 v28, s[8:11], s73 offen lds
    s_waitcnt vmcnt(8)
    s_barrier
    s_waitcnt lgkmcnt(0)
    v_mfma_f32_16x16x32_bf16 v[60:63], v[92:95], a[48:51], v[60:63]
    ds_read_b64_tr_b16 v[108:109], v128
    v_mfma_f32_16x16x32_bf16 v[76:79], v[92:95], a[104:107], v[76:79]
    ds_read_b64_tr_b16 v[110:111], v128 offset:2048
    v_mfma_f32_16x16x32_bf16 v[64:67], v[96:99], a[48:51], v[64:67]
    ds_read_b64_tr_b16 v[112:113], v129
    v_mfma_f32_16x16x32_bf16 v[80:83], v[96:99], a[104:107], v[80:83]
    ds_read_b64_tr_b16 v[114:115], v129 offset:2048
    v_mfma_f32_16x16x32_bf16 v[68:71], v[100:103], a[48:51], v[68:71]
    ds_read_b64_tr_b16 v[116:117], v130
    v_mfma_f32_16x16x32_bf16 v[84:87], v[100:103], a[104:107], v[84:87]
    ds_read_b64_tr_b16 v[118:119], v130 offset:2048
    v_mfma_f32_16x16x32_bf16 v[72:75], v[104:107], a[48:51], v[72:75]
    ds_read_b64_tr_b16 v[120:121], v131
    v_mfma_f32_16x16x32_bf16 v[88:91], v[104:107], a[104:107], v[88:91]
    ds_read_b64_tr_b16 v[122:123], v131 offset:2048
    s_add_u32 m0, s58, 131072
    s_add_u32 s73, s74, 1179648
    buffer_load_dwordx4 v28, s[8:11], s73 offen lds
    s_add_u32 m0, s58, 139264
    s_add_u32 s73, s74, 1376256
    buffer_load_dwordx4 v28, s[8:11], s73 offen lds
    s_waitcnt vmcnt(6)
    s_waitcnt lgkmcnt(0)
    v_mfma_f32_16x16x32_bf16 v[60:63], v[108:111], a[52:55], v[60:63]
    v_mfma_f32_16x16x32_bf16 v[76:79], v[108:111], a[108:111], v[76:79]
    v_mfma_f32_16x16x32_bf16 v[64:67], v[112:115], a[52:55], v[64:67]
    v_mfma_f32_16x16x32_bf16 v[80:83], v[112:115], a[108:111], v[80:83]
    v_mfma_f32_16x16x32_bf16 v[68:71], v[116:119], a[52:55], v[68:71]
    v_mfma_f32_16x16x32_bf16 v[84:87], v[116:119], a[108:111], v[84:87]
    v_mfma_f32_16x16x32_bf16 v[72:75], v[120:123], a[52:55], v[72:75]
    v_mfma_f32_16x16x32_bf16 v[88:91], v[120:123], a[108:111], v[88:91]
    s_add_u32 m0, s58, 0
    s_add_u32 s73, s75, 0
    buffer_load_dwordx4 v31, s[8:11], s73 offen lds
    s_add_u32 m0, s58, 8192
    s_add_u32 s73, s75, 393216
    buffer_load_dwordx4 v31, s[8:11], s73 offen lds
    s_add_u32 m0, s58, 16384
    s_add_u32 s73, s75, 786432
    buffer_load_dwordx4 v31, s[8:11], s73 offen lds
    s_add_u32 m0, s58, 24576
    s_add_u32 s73, s75, 1179648
    buffer_load_dwordx4 v31, s[8:11], s73 offen lds
    s_barrier
    s_xor_b32 s39, s36, 1
    s_mul_i32 s39, s39, 6144
    s_add_u32 s39, s39, 32768
    v_add_u32 v124, s39, v4
    ds_write_b128 v124, v[68:71]
    ds_write_b128 v124, v[72:75] offset:1024
    s_xor_b32 s39, s36, 2
    s_mul_i32 s39, s39, 6144
    s_add_u32 s39, s39, 34816
    v_add_u32 v124, s39, v4
    ds_write_b128 v124, v[76:79]
    ds_write_b128 v124, v[80:83] offset:1024
    s_xor_b32 s39, s36, 3
    s_mul_i32 s39, s39, 6144
    s_add_u32 s39, s39, 36864
    v_add_u32 v124, s39, v4
    ds_write_b128 v124, v[84:87]
    ds_write_b128 v124, v[88:91] offset:1024
    s_mul_i32 s39, s36, 6144
    s_add_u32 s39, s39, 32768
    s_waitcnt lgkmcnt(0)
    s_barrier
    v_add_u32 v124, s39, v4
    ds_read_b128 v[92:95], v124
    ds_read_b128 v[96:99], v124 offset:1024
    ds_read_b128 v[100:103], v124 offset:2048
    ds_read_b128 v[104:107], v124 offset:3072
    ds_read_b128 v[108:111], v124 offset:4096
    ds_read_b128 v[112:115], v124 offset:5120
    s_waitcnt lgkmcnt(5)
    v_pk_add_f32 v[60:61], v[60:61], v[92:93]
    v_pk_add_f32 v[62:63], v[62:63], v[94:95]
    s_waitcnt lgkmcnt(4)
    v_pk_add_f32 v[64:65], v[64:65], v[96:97]
    v_pk_add_f32 v[66:67], v[66:67], v[98:99]
    s_waitcnt lgkmcnt(3)
    v_pk_add_f32 v[60:61], v[60:61], v[100:101]
    v_pk_add_f32 v[62:63], v[62:63], v[102:103]
    s_waitcnt lgkmcnt(2)
    v_pk_add_f32 v[64:65], v[64:65], v[104:105]
    v_pk_add_f32 v[66:67], v[66:67], v[106:107]
    s_waitcnt lgkmcnt(1)
    v_pk_add_f32 v[60:61], v[60:61], v[108:109]
    v_pk_add_f32 v[62:63], v[62:63], v[110:111]
    s_waitcnt lgkmcnt(0)
    v_pk_add_f32 v[64:65], v[64:65], v[112:113]
    v_pk_add_f32 v[66:67], v[66:67], v[114:115]
    v_cvt_pk_bf16_f32 v7, v60, v61
    v_lshlrev_b32 v60, 16, v7
    v_and_b32 v61, 4294901760, v7
    v_lshlrev_b32 v26, 16, v56
    v_and_b32 v27, 4294901760, v56
    v_pk_add_f32 v[60:61], v[60:61], v[26:27]
    v_cvt_pk_bf16_f32 v128, v60, v61
    v_cvt_pk_bf16_f32 v7, v62, v63
    v_lshlrev_b32 v62, 16, v7
    v_and_b32 v63, 4294901760, v7
    v_lshlrev_b32 v26, 16, v57
    v_and_b32 v27, 4294901760, v57
    v_pk_add_f32 v[62:63], v[62:63], v[26:27]
    v_cvt_pk_bf16_f32 v129, v62, v63
    v_cvt_pk_bf16_f32 v7, v64, v65
    v_lshlrev_b32 v64, 16, v7
    v_and_b32 v65, 4294901760, v7
    v_lshlrev_b32 v26, 16, v58
    v_and_b32 v27, 4294901760, v58
    v_pk_add_f32 v[64:65], v[64:65], v[26:27]
    v_cvt_pk_bf16_f32 v130, v64, v65
    v_cvt_pk_bf16_f32 v7, v66, v67
    v_lshlrev_b32 v66, 16, v7
    v_and_b32 v67, 4294901760, v7
    v_lshlrev_b32 v26, 16, v59
    v_and_b32 v27, 4294901760, v59
    v_pk_add_f32 v[66:67], v[66:67], v[26:27]
    v_cvt_pk_bf16_f32 v131, v66, v67
    s_lshl_b32 s85, s63, 4
    s_add_u32 s85, s85, s65
    s_lshl_b32 s85, s85, 10
    s_add_u32 s85, s85, 0x600000
    buffer_store_dwordx4 v[128:131], v4, s[32:35], s85 offen sc1
    v_lshlrev_b32 v5, 16, v128
    v_and_b32 v6, 4294901760, v128
    v_add_f32 v132, v5, v6
    v_mul_f32 v133, v5, v5
    v_fmac_f32 v133, v6, v6
    v_lshlrev_b32 v5, 16, v129
    v_and_b32 v6, 4294901760, v129
    v_add_f32 v132, v132, v5
    v_add_f32 v132, v132, v6
    v_fmac_f32 v133, v5, v5
    v_fmac_f32 v133, v6, v6
    v_lshlrev_b32 v5, 16, v130
    v_and_b32 v6, 4294901760, v130
    v_add_f32 v132, v132, v5
    v_add_f32 v132, v132, v6
    v_fmac_f32 v133, v5, v5
    v_fmac_f32 v133, v6, v6
    v_lshlrev_b32 v5, 16, v131
    v_and_b32 v6, 4294901760, v131
    v_add_f32 v132, v132, v5
    v_add_f32 v132, v132, v6
    v_fmac_f32 v133, v5, v5
    v_fmac_f32 v133, v6, v6
    v_mov_b32 v5, v132
    v_mov_b32 v6, v133
    s_nop 0
    v_permlane32_swap_b32 v5, v132
    v_permlane32_swap_b32 v6, v133
    v_add_f32 v132, v132, v5
    v_add_f32 v133, v133, v6
    v_mov_b32 v5, v132
    v_mov_b32 v6, v133
    s_nop 0
    v_permlane16_swap_b32 v5, v132
    v_permlane16_swap_b32 v6, v133
    v_add_f32 v134, v132, v5
    v_add_f32 v135, v133, v6
    v_lshlrev_b32 v136, 7, v2
    v_mov_b32 v5, 0x7ff00000
    v_cmp_eq_u32 vcc, 0, v3
    s_nop 1
    v_cndmask_b32 v136, v5, v136, vcc
    s_lshl_b32 s86, s63, 11
    s_lshl_b32 s41, s65, 3
    s_add_u32 s86, s86, s41
    s_add_u32 s86, s86, 0x1b40000
    buffer_store_dwordx2 v[134:135], v136, s[32:35], s86 offen sc1
    s_lshl_b32 s82, s36, 7
    s_add_u32 s82, s82, 153600
    v_lshlrev_b32 v58, 7, v2
    v_lshl_add_u32 v58, v3, 5, v58
    s_lshl_b32 s83, s61, 11
    s_add_u32 s83, s83, 0x1b40000
    s_mul_i32 s84, s61, 16
    s_mul_i32 s40, s62, 8
    s_add_u32 s84, s84, s40
    s_lshl_b32 s84, s84, 10
    s_add_u32 s84, s84, 0x600000
    s_add_u32 s85, s84, 4096
    s_xor_b32 s39, s61, 1
    s_mul_i32 s86, s39, 16
    s_mul_i32 s40, s62, 8
    s_add_u32 s86, s86, s40
    s_lshl_b32 s86, s86, 10
    s_add_u32 s86, s86, 0x600000
    s_add_u32 s87, s86, 4096
    s_waitcnt vmcnt(0)
    s_barrier
    buffer_atomic_add v9, v11, s[32:35], s44 offen sc1
    s_mov_b32 s60, 0
    s_cmp_lg_u32 s36, 0
    s_nop 3
    s_cbranch_scc1 Linterleave_layers__linear_attn_block__dense_activation_silu__prompt_kernel_25
Linterleave_layers__linear_attn_block__dense_activation_silu__prompt_kernel_24:
    buffer_load_dword v13, v10, s[32:35], s44 offen sc1
    s_waitcnt vmcnt(0)
    v_readfirstlane_b32 s39, v13
    s_nop 4
    s_cmp_ge_u32 s39, 80
    s_cbranch_scc1 Linterleave_layers__linear_attn_block__dense_activation_silu__prompt_kernel_25
    s_sleep 2
    s_add_u32 s60, s60, 1
    s_cmp_lt_u32 s60, 0x40000
    s_cbranch_scc1 Linterleave_layers__linear_attn_block__dense_activation_silu__prompt_kernel_24
Linterleave_layers__linear_attn_block__dense_activation_silu__prompt_kernel_25:
    s_nop 3
    s_waitcnt vmcnt(0)
    s_barrier
    buffer_load_dwordx4 a[0:3], v4, s[32:35], s84 offen sc1
    buffer_load_dwordx4 a[32:35], v4, s[32:35], s86 offen sc1
    buffer_load_dwordx4 v[60:63], v58, s[32:35], s83 offen sc1
    buffer_load_dwordx4 v[64:67], v58, s[32:35], s83 offen offset:16 sc1
    buffer_load_dwordx4 a[4:7], v4, s[32:35], s84 offen offset:1024 sc1
    buffer_load_dwordx4 a[36:39], v4, s[32:35], s86 offen offset:1024 sc1
    buffer_load_dwordx4 a[8:11], v4, s[32:35], s84 offen offset:2048 sc1
    buffer_load_dwordx4 a[40:43], v4, s[32:35], s86 offen offset:2048 sc1
    buffer_load_dwordx4 a[12:15], v4, s[32:35], s84 offen offset:3072 sc1
    buffer_load_dwordx4 a[44:47], v4, s[32:35], s86 offen offset:3072 sc1
    s_waitcnt vmcnt(6)
    v_add_f32 v68, v60, v62
    v_add_f32 v69, v61, v63
    v_add_f32 v64, v64, v66
    v_add_f32 v65, v65, v67
    v_add_f32 v68, v68, v64
    v_add_f32 v69, v69, v65
    v_mov_b32 v5, v68
    v_mov_b32 v6, v69
    s_nop 0
    v_permlane32_swap_b32 v5, v68
    v_permlane32_swap_b32 v6, v69
    v_add_f32 v68, v68, v5
    v_add_f32 v69, v69, v6
    v_mov_b32 v5, v68
    v_mov_b32 v6, v69
    s_nop 0
    v_permlane16_swap_b32 v5, v68
    v_permlane16_swap_b32 v6, v69
    v_add_f32 v70, v68, v5
    v_add_f32 v71, v69, v6
    v_mul_f32 v70, 0x3b000000, v70
    v_mul_f32 v71, 0x3b000000, v71
    v_fma_f32 v71, -v70, v70, v71
    v_max_f32 v71, 0, v71
    v_cvt_pk_bf16_f32 v7, v70, v71
    v_lshlrev_b32 v70, 16, v7
    v_and_b32 v71, 4294901760, v7
    v_add_f32 v71, 0x3727c5ac, v71
    v_cvt_pk_bf16_f32 v7, v71, v71
    v_lshlrev_b32 v71, 16, v7
    v_sqrt_f32 v71, v71
    s_nop 0
    v_cvt_pk_bf16_f32 v7, v71, v71
    v_lshlrev_b32 v71, 16, v7
    v_rcp_f32 v71, v71
    v_sub_f32 v70, 0, v70
    v_mov_b32 v54, v70
    v_mov_b32 v56, v71
    v_add_u32 v53, s82, v14
    ds_write_b32 v53, v54
    ds_write_b32 v53, v56 offset:64
    s_lshl_b32 s39, s62, 15
    s_add_u32 s39, s39, 81920
    v_add_u32 v58, s39, v35
    v_add_u32 v59, s39, v36
    v_add_u32 v60, s39, v37
    v_add_u32 v61, s39, v38
    s_lshl_b32 s39, s62, 14
    v_add_u32 v62, s39, v43
    v_add_u32 v63, s39, v44
    ds_read_b64_tr_b16 a[64:65], v58
    ds_read_b64_tr_b16 a[66:67], v58 offset:2048
    ds_read_b64_tr_b16 a[68:69], v59
    ds_read_b64_tr_b16 a[70:71], v59 offset:2048
    ds_read_b64_tr_b16 a[72:73], v60
    ds_read_b64_tr_b16 a[74:75], v60 offset:2048
    ds_read_b64_tr_b16 a[76:77], v61
    ds_read_b64_tr_b16 a[78:79], v61 offset:2048
    ds_read_b64_tr_b16 a[80:81], v58 offset:4096
    ds_read_b64_tr_b16 a[82:83], v58 offset:6144
    ds_read_b64_tr_b16 a[84:85], v59 offset:4096
    ds_read_b64_tr_b16 a[86:87], v59 offset:6144
    ds_read_b64_tr_b16 a[88:89], v60 offset:4096
    ds_read_b64_tr_b16 a[90:91], v60 offset:6144
    ds_read_b64_tr_b16 a[92:93], v61 offset:4096
    ds_read_b64_tr_b16 a[94:95], v61 offset:6144
    buffer_load_dwordx4 a[16:19], v4, s[32:35], s85 offen sc1
    buffer_load_dwordx4 a[48:51], v4, s[32:35], s87 offen sc1
    s_waitcnt lgkmcnt(8)
    v_mfma_f32_16x16x32_bf16 v[64:67], a[0:3], a[64:67], 0
    ds_read_b64_tr_b16 a[96:97], v58 offset:8192
    v_mfma_f32_16x16x32_bf16 v[80:83], a[32:35], a[64:67], 0
    ds_read_b64_tr_b16 a[98:99], v58 offset:10240
    v_mfma_f32_16x16x32_bf16 v[68:71], a[0:3], a[68:71], 0
    ds_read_b64_tr_b16 a[100:101], v59 offset:8192
    v_mfma_f32_16x16x32_bf16 v[84:87], a[32:35], a[68:71], 0
    ds_read_b64_tr_b16 a[102:103], v59 offset:10240
    v_mfma_f32_16x16x32_bf16 v[72:75], a[0:3], a[72:75], 0
    ds_read_b64_tr_b16 a[104:105], v60 offset:8192
    v_mfma_f32_16x16x32_bf16 v[88:91], a[32:35], a[72:75], 0
    ds_read_b64_tr_b16 a[106:107], v60 offset:10240
    v_mfma_f32_16x16x32_bf16 v[76:79], a[0:3], a[76:79], 0
    ds_read_b64_tr_b16 a[108:109], v61 offset:8192
    v_mfma_f32_16x16x32_bf16 v[92:95], a[32:35], a[76:79], 0
    ds_read_b64_tr_b16 a[110:111], v61 offset:10240
    s_waitcnt vmcnt(6)
    buffer_load_dwordx4 a[20:23], v4, s[32:35], s85 offen offset:1024 sc1
    buffer_load_dwordx4 a[52:55], v4, s[32:35], s87 offen offset:1024 sc1
    s_waitcnt lgkmcnt(8)
    v_mfma_f32_16x16x32_bf16 v[64:67], a[4:7], a[80:83], v[64:67]
    ds_read_b64_tr_b16 a[64:65], v58 offset:12288
    v_mfma_f32_16x16x32_bf16 v[80:83], a[36:39], a[80:83], v[80:83]
    ds_read_b64_tr_b16 a[66:67], v58 offset:14336
    v_mfma_f32_16x16x32_bf16 v[68:71], a[4:7], a[84:87], v[68:71]
    ds_read_b64_tr_b16 a[68:69], v59 offset:12288
    v_mfma_f32_16x16x32_bf16 v[84:87], a[36:39], a[84:87], v[84:87]
    ds_read_b64_tr_b16 a[70:71], v59 offset:14336
    v_mfma_f32_16x16x32_bf16 v[72:75], a[4:7], a[88:91], v[72:75]
    ds_read_b64_tr_b16 a[72:73], v60 offset:12288
    v_mfma_f32_16x16x32_bf16 v[88:91], a[36:39], a[88:91], v[88:91]
    ds_read_b64_tr_b16 a[74:75], v60 offset:14336
    v_mfma_f32_16x16x32_bf16 v[76:79], a[4:7], a[92:95], v[76:79]
    ds_read_b64_tr_b16 a[76:77], v61 offset:12288
    v_mfma_f32_16x16x32_bf16 v[92:95], a[36:39], a[92:95], v[92:95]
    ds_read_b64_tr_b16 a[78:79], v61 offset:14336
    s_waitcnt vmcnt(6)
    buffer_load_dwordx4 a[24:27], v4, s[32:35], s85 offen offset:2048 sc1
    buffer_load_dwordx4 a[56:59], v4, s[32:35], s87 offen offset:2048 sc1
    s_waitcnt lgkmcnt(8)
    v_mfma_f32_16x16x32_bf16 v[64:67], a[8:11], a[96:99], v[64:67]
    ds_read_b64_tr_b16 a[80:81], v58 offset:16384
    v_mfma_f32_16x16x32_bf16 v[80:83], a[40:43], a[96:99], v[80:83]
    ds_read_b64_tr_b16 a[82:83], v58 offset:18432
    v_mfma_f32_16x16x32_bf16 v[68:71], a[8:11], a[100:103], v[68:71]
    ds_read_b64_tr_b16 a[84:85], v59 offset:16384
    v_mfma_f32_16x16x32_bf16 v[84:87], a[40:43], a[100:103], v[84:87]
    ds_read_b64_tr_b16 a[86:87], v59 offset:18432
    v_mfma_f32_16x16x32_bf16 v[72:75], a[8:11], a[104:107], v[72:75]
    ds_read_b64_tr_b16 a[88:89], v60 offset:16384
    v_mfma_f32_16x16x32_bf16 v[88:91], a[40:43], a[104:107], v[88:91]
    ds_read_b64_tr_b16 a[90:91], v60 offset:18432
    v_mfma_f32_16x16x32_bf16 v[76:79], a[8:11], a[108:111], v[76:79]
    ds_read_b64_tr_b16 a[92:93], v61 offset:16384
    v_mfma_f32_16x16x32_bf16 v[92:95], a[40:43], a[108:111], v[92:95]
    ds_read_b64_tr_b16 a[94:95], v61 offset:18432
    s_waitcnt vmcnt(6)
    buffer_load_dwordx4 a[28:31], v4, s[32:35], s85 offen offset:3072 sc1
    buffer_load_dwordx4 a[60:63], v4, s[32:35], s87 offen offset:3072 sc1
    s_waitcnt lgkmcnt(8)
    v_mfma_f32_16x16x32_bf16 v[64:67], a[12:15], a[64:67], v[64:67]
    ds_read_b64_tr_b16 a[96:97], v58 offset:20480
    v_mfma_f32_16x16x32_bf16 v[80:83], a[44:47], a[64:67], v[80:83]
    ds_read_b64_tr_b16 a[98:99], v58 offset:22528
    v_mfma_f32_16x16x32_bf16 v[68:71], a[12:15], a[68:71], v[68:71]
    ds_read_b64_tr_b16 a[100:101], v59 offset:20480
    v_mfma_f32_16x16x32_bf16 v[84:87], a[44:47], a[68:71], v[84:87]
    ds_read_b64_tr_b16 a[102:103], v59 offset:22528
    v_mfma_f32_16x16x32_bf16 v[72:75], a[12:15], a[72:75], v[72:75]
    ds_read_b64_tr_b16 a[104:105], v60 offset:20480
    v_mfma_f32_16x16x32_bf16 v[88:91], a[44:47], a[72:75], v[88:91]
    ds_read_b64_tr_b16 a[106:107], v60 offset:22528
    v_mfma_f32_16x16x32_bf16 v[76:79], a[12:15], a[76:79], v[76:79]
    ds_read_b64_tr_b16 a[108:109], v61 offset:20480
    v_mfma_f32_16x16x32_bf16 v[92:95], a[44:47], a[76:79], v[92:95]
    ds_read_b64_tr_b16 a[110:111], v61 offset:22528
    s_waitcnt vmcnt(6)
    s_waitcnt lgkmcnt(8)
    v_mfma_f32_16x16x32_bf16 v[64:67], a[16:19], a[80:83], v[64:67]
    ds_read_b64_tr_b16 a[64:65], v58 offset:24576
    v_mfma_f32_16x16x32_bf16 v[80:83], a[48:51], a[80:83], v[80:83]
    ds_read_b64_tr_b16 a[66:67], v58 offset:26624
    v_mfma_f32_16x16x32_bf16 v[68:71], a[16:19], a[84:87], v[68:71]
    ds_read_b64_tr_b16 a[68:69], v59 offset:24576
    v_mfma_f32_16x16x32_bf16 v[84:87], a[48:51], a[84:87], v[84:87]
    ds_read_b64_tr_b16 a[70:71], v59 offset:26624
    v_mfma_f32_16x16x32_bf16 v[72:75], a[16:19], a[88:91], v[72:75]
    ds_read_b64_tr_b16 a[72:73], v60 offset:24576
    v_mfma_f32_16x16x32_bf16 v[88:91], a[48:51], a[88:91], v[88:91]
    ds_read_b64_tr_b16 a[74:75], v60 offset:26624
    v_mfma_f32_16x16x32_bf16 v[76:79], a[16:19], a[92:95], v[76:79]
    ds_read_b64_tr_b16 a[76:77], v61 offset:24576
    v_mfma_f32_16x16x32_bf16 v[92:95], a[48:51], a[92:95], v[92:95]
    ds_read_b64_tr_b16 a[78:79], v61 offset:26624
    s_waitcnt vmcnt(4)
    s_waitcnt lgkmcnt(8)
    v_mfma_f32_16x16x32_bf16 v[64:67], a[20:23], a[96:99], v[64:67]
    ds_read_b64_tr_b16 a[80:81], v58 offset:28672
    v_mfma_f32_16x16x32_bf16 v[80:83], a[52:55], a[96:99], v[80:83]
    ds_read_b64_tr_b16 a[82:83], v58 offset:30720
    v_mfma_f32_16x16x32_bf16 v[68:71], a[20:23], a[100:103], v[68:71]
    ds_read_b64_tr_b16 a[84:85], v59 offset:28672
    v_mfma_f32_16x16x32_bf16 v[84:87], a[52:55], a[100:103], v[84:87]
    ds_read_b64_tr_b16 a[86:87], v59 offset:30720
    v_mfma_f32_16x16x32_bf16 v[72:75], a[20:23], a[104:107], v[72:75]
    ds_read_b64_tr_b16 a[88:89], v60 offset:28672
    v_mfma_f32_16x16x32_bf16 v[88:91], a[52:55], a[104:107], v[88:91]
    ds_read_b64_tr_b16 a[90:91], v60 offset:30720
    v_mfma_f32_16x16x32_bf16 v[76:79], a[20:23], a[108:111], v[76:79]
    ds_read_b64_tr_b16 a[92:93], v61 offset:28672
    v_mfma_f32_16x16x32_bf16 v[92:95], a[52:55], a[108:111], v[92:95]
    ds_read_b64_tr_b16 a[94:95], v61 offset:30720
    s_waitcnt vmcnt(2)
    s_waitcnt lgkmcnt(8)
    v_mfma_f32_16x16x32_bf16 v[64:67], a[24:27], a[64:67], v[64:67]
    v_mfma_f32_16x16x32_bf16 v[80:83], a[56:59], a[64:67], v[80:83]
    v_mfma_f32_16x16x32_bf16 v[68:71], a[24:27], a[68:71], v[68:71]
    v_mfma_f32_16x16x32_bf16 v[84:87], a[56:59], a[68:71], v[84:87]
    v_mfma_f32_16x16x32_bf16 v[72:75], a[24:27], a[72:75], v[72:75]
    v_mfma_f32_16x16x32_bf16 v[88:91], a[56:59], a[72:75], v[88:91]
    v_mfma_f32_16x16x32_bf16 v[76:79], a[24:27], a[76:79], v[76:79]
    v_mfma_f32_16x16x32_bf16 v[92:95], a[56:59], a[76:79], v[92:95]
    s_waitcnt vmcnt(0)
    s_waitcnt lgkmcnt(0)
    v_mfma_f32_16x16x32_bf16 v[64:67], a[28:31], a[80:83], v[64:67]
    v_mfma_f32_16x16x32_bf16 v[80:83], a[60:63], a[80:83], v[80:83]
    v_mfma_f32_16x16x32_bf16 v[68:71], a[28:31], a[84:87], v[68:71]
    v_mfma_f32_16x16x32_bf16 v[84:87], a[60:63], a[84:87], v[84:87]
    v_mfma_f32_16x16x32_bf16 v[72:75], a[28:31], a[88:91], v[72:75]
    v_mfma_f32_16x16x32_bf16 v[88:91], a[60:63], a[88:91], v[88:91]
    v_mfma_f32_16x16x32_bf16 v[76:79], a[28:31], a[92:95], v[76:79]
    v_mfma_f32_16x16x32_bf16 v[92:95], a[60:63], a[92:95], v[92:95]
    s_mul_i32 s39, s36, 4096
    s_add_u32 s39, s39, 32768
    v_add_u32 v96, s39, v4
    ds_write_b128 v96, v[80:83]
    ds_write_b128 v96, v[84:87] offset:1024
    s_nop 0
    ds_write_b128 v96, v[88:91] offset:2048
    s_nop 0
    ds_write_b128 v96, v[92:95] offset:3072
    s_xor_b32 s39, s36, 1
    s_mul_i32 s39, s39, 4096
    s_add_u32 s39, s39, 32768
    s_waitcnt lgkmcnt(0)
    s_barrier
    v_add_u32 v96, s39, v4
    ds_read_b128 v[80:83], v96
    ds_read_b128 v[84:87], v96 offset:1024
    ds_read_b128 v[88:91], v96 offset:2048
    ds_read_b128 v[92:95], v96 offset:3072
    v_add_u32 v53, s82, v15
    ds_read_b128 v[100:103], v53
    ds_read_b128 v[104:107], v53 offset:64
    v_add_u32 v53, 147456, v14
    ds_read_b32 v108, v53
    ds_read_b32 v110, v53 offset:64
    ds_read_b32 v112, v53 offset:128
    ds_read_b32 v114, v53 offset:192
    v_add_u32 v53, 147456, v15
    ds_read_b128 v[116:119], v53 offset:256
    ds_read_b128 v[120:123], v53 offset:320
    s_waitcnt lgkmcnt(11)
    v_pk_add_f32 v[64:65], v[64:65], v[80:81]
    v_pk_add_f32 v[66:67], v[66:67], v[82:83]
    s_waitcnt lgkmcnt(10)
    v_pk_add_f32 v[68:69], v[68:69], v[84:85]
    v_pk_add_f32 v[70:71], v[70:71], v[86:87]
    s_waitcnt lgkmcnt(9)
    v_pk_add_f32 v[72:73], v[72:73], v[88:89]
    v_pk_add_f32 v[74:75], v[74:75], v[90:91]
    s_waitcnt lgkmcnt(8)
    v_pk_add_f32 v[76:77], v[76:77], v[92:93]
    v_pk_add_f32 v[78:79], v[78:79], v[94:95]
    s_waitcnt lgkmcnt(0)
    v_pk_fma_f32 v[64:65], v[100:101], v[108:109], v[64:65] op_sel_hi:[1,0,1]
    v_pk_mul_f32 v[64:65], v[64:65], v[104:105]
    v_cvt_pk_bf16_f32 v7, v64, v65
    v_lshlrev_b32 v64, 16, v7
    v_and_b32 v65, 4294901760, v7
    v_min_f32 v26, 0, v64
    v_min_f32 v27, 0, v65
    v_pk_mul_f32 v[26:27], v[26:27], s[50:51]
    v_exp_f32 v26, v26
    v_exp_f32 v27, v27
    v_max_f32 v64, 0, v64
    v_max_f32 v65, 0, v65
    v_pk_add_f32 v[64:65], v[64:65], v[26:27]
    v_cvt_pk_bf16_f32 v7, v64, v65
    v_lshlrev_b32 v64, 16, v7
    v_and_b32 v65, 4294901760, v7
    v_pk_add_f32 v[64:65], v[64:65], s[54:55]
    v_cvt_pk_bf16_f32 v124, v64, v65
    v_pk_fma_f32 v[66:67], v[102:103], v[108:109], v[66:67] op_sel_hi:[1,0,1]
    v_pk_mul_f32 v[66:67], v[66:67], v[106:107]
    v_cvt_pk_bf16_f32 v7, v66, v67
    v_lshlrev_b32 v66, 16, v7
    v_and_b32 v67, 4294901760, v7
    v_min_f32 v26, 0, v66
    v_min_f32 v27, 0, v67
    v_pk_mul_f32 v[26:27], v[26:27], s[50:51]
    v_exp_f32 v26, v26
    v_exp_f32 v27, v27
    v_max_f32 v66, 0, v66
    v_max_f32 v67, 0, v67
    v_pk_add_f32 v[66:67], v[66:67], v[26:27]
    v_cvt_pk_bf16_f32 v7, v66, v67
    v_lshlrev_b32 v66, 16, v7
    v_and_b32 v67, 4294901760, v7
    v_pk_add_f32 v[66:67], v[66:67], s[54:55]
    v_cvt_pk_bf16_f32 v125, v66, v67
    v_pk_fma_f32 v[68:69], v[100:101], v[110:111], v[68:69] op_sel_hi:[1,0,1]
    v_pk_mul_f32 v[68:69], v[68:69], v[104:105]
    v_cvt_pk_bf16_f32 v7, v68, v69
    v_lshlrev_b32 v68, 16, v7
    v_and_b32 v69, 4294901760, v7
    v_min_f32 v26, 0, v68
    v_min_f32 v27, 0, v69
    v_pk_mul_f32 v[26:27], v[26:27], s[50:51]
    v_exp_f32 v26, v26
    v_exp_f32 v27, v27
    v_max_f32 v68, 0, v68
    v_max_f32 v69, 0, v69
    v_pk_add_f32 v[68:69], v[68:69], v[26:27]
    v_cvt_pk_bf16_f32 v7, v68, v69
    v_lshlrev_b32 v68, 16, v7
    v_and_b32 v69, 4294901760, v7
    v_pk_add_f32 v[68:69], v[68:69], s[54:55]
    v_cvt_pk_bf16_f32 v126, v68, v69
    v_pk_fma_f32 v[70:71], v[102:103], v[110:111], v[70:71] op_sel_hi:[1,0,1]
    v_pk_mul_f32 v[70:71], v[70:71], v[106:107]
    v_cvt_pk_bf16_f32 v7, v70, v71
    v_lshlrev_b32 v70, 16, v7
    v_and_b32 v71, 4294901760, v7
    v_min_f32 v26, 0, v70
    v_min_f32 v27, 0, v71
    v_pk_mul_f32 v[26:27], v[26:27], s[50:51]
    v_exp_f32 v26, v26
    v_exp_f32 v27, v27
    v_max_f32 v70, 0, v70
    v_max_f32 v71, 0, v71
    v_pk_add_f32 v[70:71], v[70:71], v[26:27]
    v_cvt_pk_bf16_f32 v7, v70, v71
    v_lshlrev_b32 v70, 16, v7
    v_and_b32 v71, 4294901760, v7
    v_pk_add_f32 v[70:71], v[70:71], s[54:55]
    v_cvt_pk_bf16_f32 v127, v70, v71
    v_pk_fma_f32 v[72:73], v[100:101], v[112:113], v[72:73] op_sel_hi:[1,0,1]
    v_pk_mul_f32 v[72:73], v[72:73], v[104:105]
    v_cvt_pk_bf16_f32 v128, v72, v73
    v_pk_fma_f32 v[74:75], v[102:103], v[112:113], v[74:75] op_sel_hi:[1,0,1]
    v_pk_mul_f32 v[74:75], v[74:75], v[106:107]
    v_cvt_pk_bf16_f32 v129, v74, v75
    v_pk_fma_f32 v[76:77], v[100:101], v[114:115], v[76:77] op_sel_hi:[1,0,1]
    v_pk_mul_f32 v[76:77], v[76:77], v[104:105]
    v_cvt_pk_bf16_f32 v130, v76, v77
    v_pk_fma_f32 v[78:79], v[102:103], v[114:115], v[78:79] op_sel_hi:[1,0,1]
    v_pk_mul_f32 v[78:79], v[78:79], v[106:107]
    v_cvt_pk_bf16_f32 v131, v78, v79
    v_mfma_f32_16x16x16_bf16 v[64:67], v[128:129], v[124:125], 0
    v_mfma_f32_16x16x16_bf16 v[72:75], v[16:17], v[124:125], 0
    v_mfma_f32_16x16x16_bf16 v[68:71], v[130:131], v[126:127], 0
    v_mfma_f32_16x16x16_bf16 v[76:79], v[16:17], v[126:127], 0
    s_mul_i32 s39, s36, 2560
    s_add_u32 s39, s39, 126976
    v_add_u32 v58, s39, v4
    v_lshlrev_b32 v59, 2, v1
    v_add_u32 v59, s39, v59
    ds_write_b128 v58, v[64:67]
    ds_write_b32 v59, v72 offset:2048
    ds_write_b128 v58, v[68:71] offset:1024
    ds_write_b32 v59, v76 offset:2304
    s_waitcnt lgkmcnt(0)
    s_barrier
    s_and_b32 s39, s36, 1
    s_lshr_b32 s40, s36, 1
    s_lshl_b32 s88, s39, 10
    s_lshl_b32 s89, s40, 6
    s_add_u32 s88, s88, s89
    s_add_u32 s88, s88, 126976
    s_lshl_b32 s89, s39, 8
    s_add_u32 s89, s89, 129024
    v_lshlrev_b32 v58, 8, v3
    v_and_b32 v5, 3, v1
    v_lshl_add_u32 v58, v5, 4, v58
    v_bfe_u32 v5, v1, 2, 2
    v_lshl_add_u32 v58, v5, 2, v58
    v_add_u32 v58, s88, v58
    v_lshlrev_b32 v59, 2, v1
    v_add_u32 v59, s89, v59
    ds_read_b32 v80, v58
    ds_read_b32 v88, v59
    ds_read_b32 v81, v58 offset:2560
    ds_read_b32 v89, v59 offset:2560
    ds_read_b32 v82, v58 offset:5120
    ds_read_b32 v90, v59 offset:5120
    ds_read_b32 v83, v58 offset:7680
    ds_read_b32 v91, v59 offset:7680
    ds_read_b32 v84, v58 offset:10240
    ds_read_b32 v92, v59 offset:10240
    ds_read_b32 v85, v58 offset:12800
    ds_read_b32 v93, v59 offset:12800
    ds_read_b32 v86, v58 offset:15360
    ds_read_b32 v94, v59 offset:15360
    ds_read_b32 v87, v58 offset:17920
    ds_read_b32 v95, v59 offset:17920
    s_lshl_b32 s90, s43, 1
    s_add_u32 s90, s90, s39
    s_lshl_b32 s91, s90, 6
    s_add_u32 s91, s91, 0x1a18000
    s_lshl_b32 s90, s90, 10
    s_lshl_b32 s39, s40, 8
    s_add_u32 s90, s90, s39
    s_add_u32 s90, s90, 0x1a10000
    s_cmp_eq_u32 s40, 0
    s_cselect_b32 s91, s91, 0x7ff00000
    v_lshlrev_b32 v60, 2, v1
    v_mov_b32 v5, 0x7ff00000
    v_cmp_gt_u32 vcc, 16, v1
    s_nop 1
    v_cndmask_b32 v61, v5, v60, vcc
    s_waitcnt lgkmcnt(0)
    v_add_f32 v80, v80, v81
    v_add_f32 v82, v82, v83
    v_add_f32 v84, v84, v85
    v_add_f32 v86, v86, v87
    v_add_f32 v80, v80, v82
    v_add_f32 v84, v84, v86
    v_add_f32 v80, v80, v84
    v_add_f32 v88, v88, v89
    v_add_f32 v90, v90, v91
    v_add_f32 v92, v92, v93
    v_add_f32 v94, v94, v95
    v_add_f32 v88, v88, v90
    v_add_f32 v92, v92, v94
    v_add_f32 v88, v88, v92
    buffer_atomic_add_f32 v80, v60, s[32:35], s90 offen
    buffer_atomic_add_f32 v88, v61, s[32:35], s91 offen
    ds_read_b64_tr_b16 a[64:65], v62
    ds_read_b64_tr_b16 a[66:67], v62 offset:1024
    ds_read_b64_tr_b16 a[68:69], v63
    ds_read_b64_tr_b16 a[70:71], v63 offset:1024
    ds_read_b64_tr_b16 a[80:81], v62 offset:2048
    ds_read_b64_tr_b16 a[82:83], v62 offset:3072
    ds_read_b64_tr_b16 a[84:85], v63 offset:2048
    ds_read_b64_tr_b16 a[86:87], v63 offset:3072
    s_waitcnt lgkmcnt(4)
    v_mfma_f32_16x16x32_bf16 v[64:67], a[64:67], a[0:3], 0
    ds_read_b64_tr_b16 a[96:97], v62 offset:4096
    v_mfma_f32_16x16x32_bf16 v[72:75], a[64:67], a[32:35], 0
    ds_read_b64_tr_b16 a[98:99], v62 offset:5120
    v_mfma_f32_16x16x32_bf16 v[68:71], a[68:71], a[0:3], 0
    ds_read_b64_tr_b16 a[100:101], v63 offset:4096
    v_mfma_f32_16x16x32_bf16 v[76:79], a[68:71], a[32:35], 0
    ds_read_b64_tr_b16 a[102:103], v63 offset:5120
    s_waitcnt lgkmcnt(4)
    v_mfma_f32_16x16x32_bf16 v[64:67], a[80:83], a[4:7], v[64:67]
    ds_read_b64_tr_b16 a[64:65], v62 offset:6144
    v_mfma_f32_16x16x32_bf16 v[72:75], a[80:83], a[36:39], v[72:75]
    ds_read_b64_tr_b16 a[66:67], v62 offset:7168
    v_mfma_f32_16x16x32_bf16 v[68:71], a[84:87], a[4:7], v[68:71]
    ds_read_b64_tr_b16 a[68:69], v63 offset:6144
    v_mfma_f32_16x16x32_bf16 v[76:79], a[84:87], a[36:39], v[76:79]
    ds_read_b64_tr_b16 a[70:71], v63 offset:7168
    s_waitcnt lgkmcnt(4)
    v_mfma_f32_16x16x32_bf16 v[64:67], a[96:99], a[8:11], v[64:67]
    ds_read_b64_tr_b16 a[80:81], v62 offset:8192
    v_mfma_f32_16x16x32_bf16 v[72:75], a[96:99], a[40:43], v[72:75]
    ds_read_b64_tr_b16 a[82:83], v62 offset:9216
    v_mfma_f32_16x16x32_bf16 v[68:71], a[100:103], a[8:11], v[68:71]
    ds_read_b64_tr_b16 a[84:85], v63 offset:8192
    v_mfma_f32_16x16x32_bf16 v[76:79], a[100:103], a[40:43], v[76:79]
    ds_read_b64_tr_b16 a[86:87], v63 offset:9216
    s_waitcnt lgkmcnt(4)
    v_mfma_f32_16x16x32_bf16 v[64:67], a[64:67], a[12:15], v[64:67]
    ds_read_b64_tr_b16 a[96:97], v62 offset:10240
    v_mfma_f32_16x16x32_bf16 v[72:75], a[64:67], a[44:47], v[72:75]
    ds_read_b64_tr_b16 a[98:99], v62 offset:11264
    v_mfma_f32_16x16x32_bf16 v[68:71], a[68:71], a[12:15], v[68:71]
    ds_read_b64_tr_b16 a[100:101], v63 offset:10240
    v_mfma_f32_16x16x32_bf16 v[76:79], a[68:71], a[44:47], v[76:79]
    ds_read_b64_tr_b16 a[102:103], v63 offset:11264
    s_waitcnt lgkmcnt(4)
    v_mfma_f32_16x16x32_bf16 v[64:67], a[80:83], a[16:19], v[64:67]
    ds_read_b64_tr_b16 a[64:65], v62 offset:12288
    v_mfma_f32_16x16x32_bf16 v[72:75], a[80:83], a[48:51], v[72:75]
    ds_read_b64_tr_b16 a[66:67], v62 offset:13312
    v_mfma_f32_16x16x32_bf16 v[68:71], a[84:87], a[16:19], v[68:71]
    ds_read_b64_tr_b16 a[68:69], v63 offset:12288
    v_mfma_f32_16x16x32_bf16 v[76:79], a[84:87], a[48:51], v[76:79]
    ds_read_b64_tr_b16 a[70:71], v63 offset:13312
    s_waitcnt lgkmcnt(4)
    v_mfma_f32_16x16x32_bf16 v[64:67], a[96:99], a[20:23], v[64:67]
    ds_read_b64_tr_b16 a[80:81], v62 offset:14336
    v_mfma_f32_16x16x32_bf16 v[72:75], a[96:99], a[52:55], v[72:75]
    ds_read_b64_tr_b16 a[82:83], v62 offset:15360
    v_mfma_f32_16x16x32_bf16 v[68:71], a[100:103], a[20:23], v[68:71]
    ds_read_b64_tr_b16 a[84:85], v63 offset:14336
    v_mfma_f32_16x16x32_bf16 v[76:79], a[100:103], a[52:55], v[76:79]
    ds_read_b64_tr_b16 a[86:87], v63 offset:15360
    s_waitcnt lgkmcnt(4)
    v_mfma_f32_16x16x32_bf16 v[64:67], a[64:67], a[24:27], v[64:67]
    v_mfma_f32_16x16x32_bf16 v[72:75], a[64:67], a[56:59], v[72:75]
    v_mfma_f32_16x16x32_bf16 v[68:71], a[68:71], a[24:27], v[68:71]
    v_mfma_f32_16x16x32_bf16 v[76:79], a[68:71], a[56:59], v[76:79]
    s_waitcnt lgkmcnt(0)
    v_mfma_f32_16x16x32_bf16 v[64:67], a[80:83], a[28:31], v[64:67]
    v_mfma_f32_16x16x32_bf16 v[72:75], a[80:83], a[60:63], v[72:75]
    v_mfma_f32_16x16x32_bf16 v[68:71], a[84:87], a[28:31], v[68:71]
    v_mfma_f32_16x16x32_bf16 v[76:79], a[84:87], a[60:63], v[76:79]
    s_waitcnt vmcnt(0)
    s_mul_i32 s39, s36, 4096
    s_add_u32 s39, s39, 32768
    v_add_u32 v132, s39, v4
    s_nop 1
    ds_write_b128 v132, v[72:75]
    s_nop 0
    ds_write_b128 v132, v[76:79] offset:1024
    s_xor_b32 s39, s36, 1
    s_mul_i32 s39, s39, 4096
    s_add_u32 s39, s39, 32768
    s_waitcnt lgkmcnt(0)
    s_barrier
    v_add_u32 v132, s39, v4
    ds_read_b128 v[72:75], v132
    ds_read_b128 v[76:79], v132 offset:1024
    s_cmp_lg_u32 s36, 0
    s_nop 3
    s_cbranch_scc1 Linterleave_layers__linear_attn_block__dense_activation_silu__prompt_kernel_26
    v_mov_b32 v13, 1
    buffer_atomic_add v13, v11, s[32:35], s44 offen offset:192 sc0 sc1
    s_waitcnt vmcnt(0)
    v_readfirstlane_b32 s39, v13
    s_nop 4
    s_cmp_lg_u32 s39, 31
    s_cbranch_scc1 Linterleave_layers__linear_attn_block__dense_activation_silu__prompt_kernel_26
    v_mov_b32 v13, 2
    buffer_store_dword v13, v12, s[32:35], s45 offen sc1
Linterleave_layers__linear_attn_block__dense_activation_silu__prompt_kernel_26:
    s_nop 3
    s_waitcnt lgkmcnt(1)
    v_pk_add_f32 v[64:65], v[64:65], v[72:73]
    v_pk_add_f32 v[66:67], v[66:67], v[74:75]
    s_waitcnt lgkmcnt(0)
    v_pk_add_f32 v[68:69], v[68:69], v[76:77]
    v_pk_add_f32 v[70:71], v[70:71], v[78:79]
    v_pk_fma_f32 v[64:65], v[116:117], v[54:55], v[64:65] op_sel_hi:[1,0,1]
    v_pk_mul_f32 v[64:65], v[64:65], v[56:57] op_sel_hi:[1,0]
    v_cvt_pk_bf16_f32 v7, v64, v65
    v_lshlrev_b32 v64, 16, v7
    v_and_b32 v65, 4294901760, v7
    v_min_f32 v26, 0, v64
    v_min_f32 v27, 0, v65
    v_pk_mul_f32 v[26:27], v[26:27], s[50:51]
    s_add_u32 m0, s58, 81920
    s_add_u32 s73, s76, 0
    buffer_load_dwordx4 v30, s[12:15], s73 offen lds
    v_exp_f32 v26, v26
    v_exp_f32 v27, v27
    v_max_f32 v64, 0, v64
    v_max_f32 v65, 0, v65
    v_pk_add_f32 v[64:65], v[64:65], v[26:27]
    v_cvt_pk_bf16_f32 v7, v64, v65
    v_lshlrev_b32 v64, 16, v7
    v_and_b32 v65, 4294901760, v7
    v_pk_add_f32 v[64:65], v[64:65], s[54:55]
    v_cvt_pk_bf16_f32 v100, v64, v65
    v_pk_fma_f32 v[66:67], v[118:119], v[54:55], v[66:67] op_sel_hi:[1,0,1]
    v_pk_mul_f32 v[66:67], v[66:67], v[56:57] op_sel_hi:[1,0]
    s_add_u32 m0, s58, 90112
    s_add_u32 s73, s76, 65536
    buffer_load_dwordx4 v30, s[12:15], s73 offen lds
    v_cvt_pk_bf16_f32 v7, v66, v67
    v_lshlrev_b32 v66, 16, v7
    v_and_b32 v67, 4294901760, v7
    v_min_f32 v26, 0, v66
    v_min_f32 v27, 0, v67
    v_pk_mul_f32 v[26:27], v[26:27], s[50:51]
    v_exp_f32 v26, v26
    v_exp_f32 v27, v27
    v_max_f32 v66, 0, v66
    v_max_f32 v67, 0, v67
    v_pk_add_f32 v[66:67], v[66:67], v[26:27]
    v_cvt_pk_bf16_f32 v7, v66, v67
    s_add_u32 m0, s58, 98304
    s_add_u32 s73, s76, 131072
    buffer_load_dwordx4 v30, s[12:15], s73 offen lds
    v_lshlrev_b32 v66, 16, v7
    v_and_b32 v67, 4294901760, v7
    v_pk_add_f32 v[66:67], v[66:67], s[54:55]
    v_cvt_pk_bf16_f32 v101, v66, v67
    v_pk_fma_f32 v[68:69], v[120:121], v[54:55], v[68:69] op_sel_hi:[1,0,1]
    v_pk_mul_f32 v[68:69], v[68:69], v[56:57] op_sel_hi:[1,0]
    v_cvt_pk_bf16_f32 v7, v68, v69
    v_lshlrev_b32 v68, 16, v7
    v_and_b32 v69, 4294901760, v7
    v_min_f32 v26, 0, v68
    v_min_f32 v27, 0, v69
    v_pk_mul_f32 v[26:27], v[26:27], s[50:51]
    s_add_u32 m0, s58, 106496
    s_add_u32 s73, s76, 196608
    buffer_load_dwordx4 v30, s[12:15], s73 offen lds
    v_exp_f32 v26, v26
    v_exp_f32 v27, v27
    v_max_f32 v68, 0, v68
    v_max_f32 v69, 0, v69
    v_pk_add_f32 v[68:69], v[68:69], v[26:27]
    v_cvt_pk_bf16_f32 v7, v68, v69
    v_lshlrev_b32 v68, 16, v7
    v_and_b32 v69, 4294901760, v7
    v_pk_add_f32 v[68:69], v[68:69], s[54:55]
    v_cvt_pk_bf16_f32 v102, v68, v69
    v_pk_fma_f32 v[70:71], v[122:123], v[54:55], v[70:71] op_sel_hi:[1,0,1]
    v_pk_mul_f32 v[70:71], v[70:71], v[56:57] op_sel_hi:[1,0]
    s_add_u32 m0, s58, 114688
    s_add_u32 s73, s76, 262144
    buffer_load_dwordx4 v30, s[12:15], s73 offen lds
    v_cvt_pk_bf16_f32 v7, v70, v71
    v_lshlrev_b32 v70, 16, v7
    v_and_b32 v71, 4294901760, v7
    v_min_f32 v26, 0, v70
    v_min_f32 v27, 0, v71
    v_pk_mul_f32 v[26:27], v[26:27], s[50:51]
    v_exp_f32 v26, v26
    v_exp_f32 v27, v27
    v_max_f32 v70, 0, v70
    v_max_f32 v71, 0, v71
    v_pk_add_f32 v[70:71], v[70:71], v[26:27]
    v_cvt_pk_bf16_f32 v7, v70, v71
    s_add_u32 m0, s58, 122880
    s_add_u32 s73, s76, 327680
    buffer_load_dwordx4 v30, s[12:15], s73 offen lds
    v_lshlrev_b32 v70, 16, v7
    v_and_b32 v71, 4294901760, v7
    v_pk_add_f32 v[70:71], v[70:71], s[54:55]
    v_cvt_pk_bf16_f32 v103, v70, v71
    s_lshl_b32 s92, s61, 4
    s_add_u32 s92, s92, s43
    s_lshl_b32 s92, s92, 10
    s_add_u32 s92, s92, 0x200000
    buffer_store_dwordx4 v[100:103], v4, s[32:35], s92 offen sc1
    s_lshl_b32 s82, s36, 12
    s_add_u32 s82, s82, 0x1a10000
    s_lshl_b32 s83, s36, 8
    s_add_u32 s83, s83, 0x1a18000
    v_lshlrev_b32 v76, 4, v2
    s_lshl_b32 s84, s63, 4
    s_lshl_b32 s39, s62, 3
    s_add_u32 s84, s84, s39
    s_lshl_b32 s84, s84, 10
    s_add_u32 s84, s84, 0x200000
    s_add_u32 s85, s84, 4096
    s_waitcnt vmcnt(0)
    s_barrier
    buffer_atomic_add v9, v11, s[32:35], s44 offen sc1
    s_add_u32 m0, s58, 131072
    s_add_u32 s73, s76, 393216
    buffer_load_dwordx4 v30, s[12:15], s73 offen lds
    s_add_u32 m0, s58, 139264
    s_add_u32 s73, s76, 458752
    buffer_load_dwordx4 v30, s[12:15], s73 offen lds
    s_mov_b32 s60, 0
    s_cmp_lg_u32 s36, 0
    s_nop 3
    s_cbranch_scc1 Linterleave_layers__linear_attn_block__dense_activation_silu__prompt_kernel_28
Linterleave_layers__linear_attn_block__dense_activation_silu__prompt_kernel_27:
    buffer_load_dword v13, v14, s[32:35], s44 offen offset:128 sc1
    s_waitcnt vmcnt(0)
    v_cmp_gt_u32 vcc, 2, v13
    s_nop 4
    s_cmp_eq_u64 vcc, 0
    s_cbranch_scc1 Linterleave_layers__linear_attn_block__dense_activation_silu__prompt_kernel_28
    s_sleep 2
    s_add_u32 s60, s60, 1
    s_cmp_lt_u32 s60, 0x40000
    s_cbranch_scc1 Linterleave_layers__linear_attn_block__dense_activation_silu__prompt_kernel_27
Linterleave_layers__linear_attn_block__dense_activation_silu__prompt_kernel_28:
    s_nop 3
    s_mov_b32 s60, 0
    s_cmp_lg_u32 s36, 0
    s_nop 3
    s_cbranch_scc1 Linterleave_layers__linear_attn_block__dense_activation_silu__prompt_kernel_30
Linterleave_layers__linear_attn_block__dense_activation_silu__prompt_kernel_29:
    buffer_load_dword v13, v10, s[32:35], s44 offen sc1
    s_waitcnt vmcnt(0)
    v_readfirstlane_b32 s39, v13
    s_nop 4
    s_cmp_ge_u32 s39, 96
    s_cbranch_scc1 Linterleave_layers__linear_attn_block__dense_activation_silu__prompt_kernel_30
    s_sleep 2
    s_add_u32 s60, s60, 1
    s_cmp_lt_u32 s60, 0x40000
    s_cbranch_scc1 Linterleave_layers__linear_attn_block__dense_activation_silu__prompt_kernel_29
Linterleave_layers__linear_attn_block__dense_activation_silu__prompt_kernel_30:
    s_nop 3
    s_waitcnt vmcnt(0)
    s_barrier
    buffer_load_dwordx4 v[56:59], v4, s[32:35], s82 offen sc1
    buffer_load_dwordx4 v[60:63], v4, s[32:35], s82 offen offset:1024 sc1
    buffer_load_dwordx4 v[64:67], v4, s[32:35], s82 offen offset:2048 sc1
    buffer_load_dwordx4 v[68:71], v4, s[32:35], s82 offen offset:3072 sc1
    buffer_load_dwordx4 v[72:75], v76, s[32:35], s83 offen sc1
    buffer_load_dwordx4 a[0:3], v4, s[32:35], s84 offen sc1
    buffer_load_dwordx4 a[4:7], v4, s[32:35], s84 offen offset:1024 sc1
    buffer_load_dwordx4 a[8:11], v4, s[32:35], s84 offen offset:2048 sc1
    buffer_load_dwordx4 a[12:15], v4, s[32:35], s84 offen offset:3072 sc1
    buffer_load_dwordx4 a[16:19], v4, s[32:35], s85 offen sc1
    buffer_load_dwordx4 a[20:23], v4, s[32:35], s85 offen offset:1024 sc1
    buffer_load_dwordx4 a[24:27], v4, s[32:35], s85 offen offset:2048 sc1
    buffer_load_dwordx4 a[28:31], v4, s[32:35], s85 offen offset:3072 sc1
    s_lshl_b32 s86, s63, 4
    s_add_u32 s86, s86, s65
    s_lshl_b32 s86, s86, 10
    s_add_u32 s86, s86, 0x600000
    buffer_load_dwordx4 v[80:83], v4, s[32:35], s86 offen sc1
    v_lshlrev_b32 v84, 3, v1
    s_lshl_b32 s39, s36, 11
    s_add_u32 s39, s39, 65536
    v_add_u32 v84, s39, v84
    s_lshl_b32 s39, s36, 8
    s_add_u32 s39, s39, 149504
    v_add_u32 v85, s39, v76
    v_bfe_u32 v5, v1, 2, 1
    v_cmp_eq_u32 s[88:89], 1, v5
    s_waitcnt vmcnt(9)
    v_cvt_pk_bf16_f32 v56, v56, v57
    v_cvt_pk_bf16_f32 v57, v58, v59
    ds_write_b64 v84, v[56:57]
    v_cvt_pk_bf16_f32 v60, v60, v61
    v_cvt_pk_bf16_f32 v61, v62, v63
    ds_write_b64 v84, v[60:61] offset:512
    v_cvt_pk_bf16_f32 v64, v64, v65
    v_cvt_pk_bf16_f32 v65, v66, v67
    ds_write_b64 v84, v[64:65] offset:1024
    v_cvt_pk_bf16_f32 v68, v68, v69
    v_cvt_pk_bf16_f32 v69, v70, v71
    ds_write_b64 v84, v[68:69] offset:1536
    v_cvt_pk_bf16_f32 v5, v72, v73
    v_cvt_pk_bf16_f32 v6, v74, v75
    v_cndmask_b32 v72, v5, v10, s[88:89]
    v_cndmask_b32 v73, v6, v10, s[88:89]
    v_cndmask_b32 v74, v10, v5, s[88:89]
    v_cndmask_b32 v75, v10, v6, s[88:89]
    ds_write_b128 v85, v[72:75]
    s_waitcnt lgkmcnt(0)
    s_barrier
    v_lshlrev_b32 v84, 3, v1
    s_lshl_b32 s39, s62, 13
    s_add_u32 s39, s39, 65536
    v_add_u32 v84, s39, v84
    v_and_b32 v5, 1, v1
    v_lshlrev_b32 v86, 6, v5
    v_lshl_add_u32 v86, v3, 4, v86
    s_lshl_b32 s39, s62, 10
    s_add_u32 s39, s39, 149504
    v_add_u32 v86, s39, v86
    ds_read_b64 a[32:33], v84
    ds_read_b64 a[34:35], v84 offset:512
    ds_read_b128 a[64:67], v86
    ds_read_b64 a[36:37], v84 offset:1024
    ds_read_b64 a[38:39], v84 offset:1536
    ds_read_b128 a[68:71], v86 offset:128
    ds_read_b64 a[40:41], v84 offset:2048
    ds_read_b64 a[42:43], v84 offset:2560
    ds_read_b128 a[72:75], v86 offset:256
    ds_read_b64 a[44:45], v84 offset:3072
    ds_read_b64 a[46:47], v84 offset:3584
    ds_read_b128 a[76:79], v86 offset:384
    ds_read_b64 a[48:49], v84 offset:4096
    ds_read_b64 a[50:51], v84 offset:4608
    ds_read_b128 a[80:83], v86 offset:512
    ds_read_b64 a[52:53], v84 offset:5120
    ds_read_b64 a[54:55], v84 offset:5632
    ds_read_b128 a[84:87], v86 offset:640
    ds_read_b64 a[56:57], v84 offset:6144
    ds_read_b64 a[58:59], v84 offset:6656
    ds_read_b128 a[88:91], v86 offset:768
    ds_read_b64 a[60:61], v84 offset:7168
    ds_read_b64 a[62:63], v84 offset:7680
    ds_read_b128 a[92:95], v86 offset:896
    s_lshl_b32 s39, s62, 15
    s_add_u32 s39, s39, 81920
    v_add_u32 v120, s39, v39
    v_add_u32 v121, s39, v40
    v_add_u32 v122, s39, v41
    v_add_u32 v123, s39, v42
    s_waitcnt lgkmcnt(15)
    s_waitcnt vmcnt(8)
    v_mfma_f32_16x16x32_bf16 v[112:115], a[64:67], a[0:3], 0
    v_mfma_f32_16x16x16_bf16 v[96:99], a[32:33], a[0:1], 0
    v_mfma_f32_16x16x16_bf16 v[100:103], a[34:35], a[2:3], 0
    s_waitcnt vmcnt(7)
    v_mfma_f32_16x16x32_bf16 v[116:119], a[68:71], a[4:7], 0
    v_mfma_f32_16x16x16_bf16 v[104:107], a[36:37], a[4:5], 0
    s_add_u32 m0, s58, 0
    s_add_u32 s73, s77, 0
    buffer_load_dwordx4 v29, s[16:19], s73 offen lds
    v_mfma_f32_16x16x16_bf16 v[108:111], a[38:39], a[6:7], 0
    ds_read_b64_tr_b16 a[96:97], v120
    ds_read_b64_tr_b16 a[98:99], v120 offset:2048
    ds_read_b64_tr_b16 a[100:101], v121
    ds_read_b64_tr_b16 a[102:103], v121 offset:2048
    ds_read_b64_tr_b16 a[104:105], v122
    ds_read_b64_tr_b16 a[106:107], v122 offset:2048
    ds_read_b64_tr_b16 a[108:109], v123
    ds_read_b64_tr_b16 a[110:111], v123 offset:2048
    v_cvt_pk_bf16_f32 v7, v112, v113
    v_lshlrev_b32 v112, 16, v7
    v_and_b32 v113, 4294901760, v7
    v_pk_add_f32 v[112:113], v[112:113], s[54:55]
    v_cvt_pk_bf16_f32 v7, v112, v113
    v_lshlrev_b32 v112, 16, v7
    v_and_b32 v113, 4294901760, v7
    v_rcp_f32 v114, v113
    v_rcp_f32 v112, v112
    s_nop 0
    v_pk_mul_f32 v[96:97], v[96:97], v[112:113] op_sel_hi:[1,0]
    v_pk_mul_f32 v[98:99], v[98:99], v[112:113] op_sel_hi:[1,0]
    v_cvt_pk_bf16_f32 v88, v96, v97
    v_cvt_pk_bf16_f32 v89, v98, v99
    v_pk_mul_f32 v[100:101], v[100:101], v[114:115] op_sel_hi:[1,0]
    v_pk_mul_f32 v[102:103], v[102:103], v[114:115] op_sel_hi:[1,0]
    v_cvt_pk_bf16_f32 v90, v100, v101
    v_cvt_pk_bf16_f32 v91, v102, v103
    s_waitcnt lgkmcnt(0)
    s_nop 0
    v_mfma_f32_16x16x32_bf16 v[56:59], a[96:99], v[88:91], 0
    s_add_u32 m0, s58, 8192
    s_add_u32 s73, s77, 229376
    buffer_load_dwordx4 v29, s[16:19], s73 offen lds
    v_mfma_f32_16x16x32_bf16 v[60:63], a[100:103], v[88:91], 0
    v_mfma_f32_16x16x32_bf16 v[64:67], a[104:107], v[88:91], 0
    v_mfma_f32_16x16x32_bf16 v[68:71], a[108:111], v[88:91], 0
    s_waitcnt vmcnt(8)
    v_mfma_f32_16x16x32_bf16 v[112:115], a[72:75], a[8:11], 0
    v_mfma_f32_16x16x16_bf16 v[96:99], a[40:41], a[8:9], 0
    v_mfma_f32_16x16x16_bf16 v[100:103], a[42:43], a[10:11], 0
    s_add_u32 m0, s58, 16384
    s_add_u32 s73, s77, 458752
    buffer_load_dwordx4 v29, s[16:19], s73 offen lds
    ds_read_b64_tr_b16 a[96:97], v120 offset:4096
    ds_read_b64_tr_b16 a[98:99], v120 offset:6144
    ds_read_b64_tr_b16 a[100:101], v121 offset:4096
    ds_read_b64_tr_b16 a[102:103], v121 offset:6144
    ds_read_b64_tr_b16 a[104:105], v122 offset:4096
    ds_read_b64_tr_b16 a[106:107], v122 offset:6144
    ds_read_b64_tr_b16 a[108:109], v123 offset:4096
    ds_read_b64_tr_b16 a[110:111], v123 offset:6144
    v_cvt_pk_bf16_f32 v7, v116, v117
    v_lshlrev_b32 v116, 16, v7
    v_and_b32 v117, 4294901760, v7
    v_pk_add_f32 v[116:117], v[116:117], s[54:55]
    v_cvt_pk_bf16_f32 v7, v116, v117
    v_lshlrev_b32 v116, 16, v7
    v_and_b32 v117, 4294901760, v7
    v_rcp_f32 v118, v117
    v_rcp_f32 v116, v116
    s_nop 0
    v_pk_mul_f32 v[104:105], v[104:105], v[116:117] op_sel_hi:[1,0]
    v_pk_mul_f32 v[106:107], v[106:107], v[116:117] op_sel_hi:[1,0]
    v_cvt_pk_bf16_f32 v92, v104, v105
    v_cvt_pk_bf16_f32 v93, v106, v107
    v_pk_mul_f32 v[108:109], v[108:109], v[118:119] op_sel_hi:[1,0]
    v_pk_mul_f32 v[110:111], v[110:111], v[118:119] op_sel_hi:[1,0]
    v_cvt_pk_bf16_f32 v94, v108, v109
    v_cvt_pk_bf16_f32 v95, v110, v111
    s_waitcnt lgkmcnt(0)
    s_nop 0
    v_mfma_f32_16x16x32_bf16 v[56:59], a[96:99], v[92:95], v[56:59]
    v_mfma_f32_16x16x32_bf16 v[60:63], a[100:103], v[92:95], v[60:63]
    s_add_u32 m0, s58, 24576
    s_add_u32 s73, s77, 688128
    buffer_load_dwordx4 v29, s[16:19], s73 offen lds
    v_mfma_f32_16x16x32_bf16 v[64:67], a[104:107], v[92:95], v[64:67]
    v_mfma_f32_16x16x32_bf16 v[68:71], a[108:111], v[92:95], v[68:71]
    s_waitcnt vmcnt(9)
    v_mfma_f32_16x16x32_bf16 v[116:119], a[76:79], a[12:15], 0
    v_mfma_f32_16x16x16_bf16 v[104:107], a[44:45], a[12:13], 0
    v_mfma_f32_16x16x16_bf16 v[108:111], a[46:47], a[14:15], 0
    ds_read_b64_tr_b16 a[96:97], v120 offset:8192
    ds_read_b64_tr_b16 a[98:99], v120 offset:10240
    ds_read_b64_tr_b16 a[100:101], v121 offset:8192
    ds_read_b64_tr_b16 a[102:103], v121 offset:10240
    ds_read_b64_tr_b16 a[104:105], v122 offset:8192
    ds_read_b64_tr_b16 a[106:107], v122 offset:10240
    ds_read_b64_tr_b16 a[108:109], v123 offset:8192
    ds_read_b64_tr_b16 a[110:111], v123 offset:10240
    v_cvt_pk_bf16_f32 v7, v112, v113
    v_lshlrev_b32 v112, 16, v7
    v_and_b32 v113, 4294901760, v7
    v_pk_add_f32 v[112:113], v[112:113], s[54:55]
    s_add_u32 m0, s58, 32768
    s_add_u32 s73, s77, 917504
    buffer_load_dwordx4 v29, s[16:19], s73 offen lds
    v_cvt_pk_bf16_f32 v7, v112, v113
    v_lshlrev_b32 v112, 16, v7
    v_and_b32 v113, 4294901760, v7
    v_rcp_f32 v114, v113
    v_rcp_f32 v112, v112
    s_nop 0
    v_pk_mul_f32 v[96:97], v[96:97], v[112:113] op_sel_hi:[1,0]
    v_pk_mul_f32 v[98:99], v[98:99], v[112:113] op_sel_hi:[1,0]
    v_cvt_pk_bf16_f32 v88, v96, v97
    v_cvt_pk_bf16_f32 v89, v98, v99
    v_pk_mul_f32 v[100:101], v[100:101], v[114:115] op_sel_hi:[1,0]
    v_pk_mul_f32 v[102:103], v[102:103], v[114:115] op_sel_hi:[1,0]
    v_cvt_pk_bf16_f32 v90, v100, v101
    v_cvt_pk_bf16_f32 v91, v102, v103
    s_waitcnt lgkmcnt(0)
    s_nop 0
    v_mfma_f32_16x16x32_bf16 v[56:59], a[96:99], v[88:91], v[56:59]
    v_mfma_f32_16x16x32_bf16 v[60:63], a[100:103], v[88:91], v[60:63]
    v_mfma_f32_16x16x32_bf16 v[64:67], a[104:107], v[88:91], v[64:67]
    s_add_u32 m0, s58, 40960
    s_add_u32 s73, s77, 1146880
    buffer_load_dwordx4 v29, s[16:19], s73 offen lds
    v_mfma_f32_16x16x32_bf16 v[68:71], a[108:111], v[88:91], v[68:71]
    s_waitcnt vmcnt(10)
    v_mfma_f32_16x16x32_bf16 v[112:115], a[80:83], a[16:19], 0
    v_mfma_f32_16x16x16_bf16 v[96:99], a[48:49], a[16:17], 0
    v_mfma_f32_16x16x16_bf16 v[100:103], a[50:51], a[18:19], 0
    ds_read_b64_tr_b16 a[96:97], v120 offset:12288
    ds_read_b64_tr_b16 a[98:99], v120 offset:14336
    ds_read_b64_tr_b16 a[100:101], v121 offset:12288
    ds_read_b64_tr_b16 a[102:103], v121 offset:14336
    ds_read_b64_tr_b16 a[104:105], v122 offset:12288
    ds_read_b64_tr_b16 a[106:107], v122 offset:14336
    ds_read_b64_tr_b16 a[108:109], v123 offset:12288
    ds_read_b64_tr_b16 a[110:111], v123 offset:14336
    v_cvt_pk_bf16_f32 v7, v116, v117
    v_lshlrev_b32 v116, 16, v7
    v_and_b32 v117, 4294901760, v7
    v_pk_add_f32 v[116:117], v[116:117], s[54:55]
    v_cvt_pk_bf16_f32 v7, v116, v117
    v_lshlrev_b32 v116, 16, v7
    v_and_b32 v117, 4294901760, v7
    v_rcp_f32 v118, v117
    s_add_u32 m0, s58, 49152
    s_add_u32 s73, s77, 1376256
    buffer_load_dwordx4 v29, s[16:19], s73 offen lds
    v_rcp_f32 v116, v116
    s_nop 0
    v_pk_mul_f32 v[104:105], v[104:105], v[116:117] op_sel_hi:[1,0]
    v_pk_mul_f32 v[106:107], v[106:107], v[116:117] op_sel_hi:[1,0]
    v_cvt_pk_bf16_f32 v92, v104, v105
    v_cvt_pk_bf16_f32 v93, v106, v107
    v_pk_mul_f32 v[108:109], v[108:109], v[118:119] op_sel_hi:[1,0]
    v_pk_mul_f32 v[110:111], v[110:111], v[118:119] op_sel_hi:[1,0]
    v_cvt_pk_bf16_f32 v94, v108, v109
    v_cvt_pk_bf16_f32 v95, v110, v111
    s_waitcnt lgkmcnt(0)
    s_nop 0
    v_mfma_f32_16x16x32_bf16 v[56:59], a[96:99], v[92:95], v[56:59]
    v_mfma_f32_16x16x32_bf16 v[60:63], a[100:103], v[92:95], v[60:63]
    v_mfma_f32_16x16x32_bf16 v[64:67], a[104:107], v[92:95], v[64:67]
    v_mfma_f32_16x16x32_bf16 v[68:71], a[108:111], v[92:95], v[68:71]
    s_add_u32 m0, s58, 57344
    s_add_u32 s73, s77, 1605632
    buffer_load_dwordx4 v29, s[16:19], s73 offen lds
    s_waitcnt vmcnt(11)
    v_mfma_f32_16x16x32_bf16 v[116:119], a[84:87], a[20:23], 0
    v_mfma_f32_16x16x16_bf16 v[104:107], a[52:53], a[20:21], 0
    v_mfma_f32_16x16x16_bf16 v[108:111], a[54:55], a[22:23], 0
    ds_read_b64_tr_b16 a[96:97], v120 offset:16384
    ds_read_b64_tr_b16 a[98:99], v120 offset:18432
    ds_read_b64_tr_b16 a[100:101], v121 offset:16384
    ds_read_b64_tr_b16 a[102:103], v121 offset:18432
    ds_read_b64_tr_b16 a[104:105], v122 offset:16384
    ds_read_b64_tr_b16 a[106:107], v122 offset:18432
    ds_read_b64_tr_b16 a[108:109], v123 offset:16384
    ds_read_b64_tr_b16 a[110:111], v123 offset:18432
    v_cvt_pk_bf16_f32 v7, v112, v113
    v_lshlrev_b32 v112, 16, v7
    v_and_b32 v113, 4294901760, v7
    v_pk_add_f32 v[112:113], v[112:113], s[54:55]
    v_cvt_pk_bf16_f32 v7, v112, v113
    v_lshlrev_b32 v112, 16, v7
    v_and_b32 v113, 4294901760, v7
    v_rcp_f32 v114, v113
    v_rcp_f32 v112, v112
    s_nop 0
    v_pk_mul_f32 v[96:97], v[96:97], v[112:113] op_sel_hi:[1,0]
    v_pk_mul_f32 v[98:99], v[98:99], v[112:113] op_sel_hi:[1,0]
    v_cvt_pk_bf16_f32 v88, v96, v97
    v_cvt_pk_bf16_f32 v89, v98, v99
    v_pk_mul_f32 v[100:101], v[100:101], v[114:115] op_sel_hi:[1,0]
    v_pk_mul_f32 v[102:103], v[102:103], v[114:115] op_sel_hi:[1,0]
    v_cvt_pk_bf16_f32 v90, v100, v101
    v_cvt_pk_bf16_f32 v91, v102, v103
    s_waitcnt lgkmcnt(0)
    s_nop 0
    v_mfma_f32_16x16x32_bf16 v[56:59], a[96:99], v[88:91], v[56:59]
    v_mfma_f32_16x16x32_bf16 v[60:63], a[100:103], v[88:91], v[60:63]
    v_mfma_f32_16x16x32_bf16 v[64:67], a[104:107], v[88:91], v[64:67]
    v_mfma_f32_16x16x32_bf16 v[68:71], a[108:111], v[88:91], v[68:71]
    s_waitcnt vmcnt(10)
    v_mfma_f32_16x16x32_bf16 v[112:115], a[88:91], a[24:27], 0
    v_mfma_f32_16x16x16_bf16 v[96:99], a[56:57], a[24:25], 0
    v_mfma_f32_16x16x16_bf16 v[100:103], a[58:59], a[26:27], 0
    ds_read_b64_tr_b16 a[96:97], v120 offset:20480
    ds_read_b64_tr_b16 a[98:99], v120 offset:22528
    ds_read_b64_tr_b16 a[100:101], v121 offset:20480
    ds_read_b64_tr_b16 a[102:103], v121 offset:22528
    ds_read_b64_tr_b16 a[104:105], v122 offset:20480
    ds_read_b64_tr_b16 a[106:107], v122 offset:22528
    ds_read_b64_tr_b16 a[108:109], v123 offset:20480
    ds_read_b64_tr_b16 a[110:111], v123 offset:22528
    v_cvt_pk_bf16_f32 v7, v116, v117
    v_lshlrev_b32 v116, 16, v7
    v_and_b32 v117, 4294901760, v7
    v_pk_add_f32 v[116:117], v[116:117], s[54:55]
    v_cvt_pk_bf16_f32 v7, v116, v117
    v_lshlrev_b32 v116, 16, v7
    v_and_b32 v117, 4294901760, v7
    v_rcp_f32 v118, v117
    v_rcp_f32 v116, v116
    s_nop 0
    v_pk_mul_f32 v[104:105], v[104:105], v[116:117] op_sel_hi:[1,0]
    v_pk_mul_f32 v[106:107], v[106:107], v[116:117] op_sel_hi:[1,0]
    v_cvt_pk_bf16_f32 v92, v104, v105
    v_cvt_pk_bf16_f32 v93, v106, v107
    v_pk_mul_f32 v[108:109], v[108:109], v[118:119] op_sel_hi:[1,0]
    v_pk_mul_f32 v[110:111], v[110:111], v[118:119] op_sel_hi:[1,0]
    v_cvt_pk_bf16_f32 v94, v108, v109
    v_cvt_pk_bf16_f32 v95, v110, v111
    s_waitcnt lgkmcnt(0)
    s_nop 0
    v_mfma_f32_16x16x32_bf16 v[56:59], a[96:99], v[92:95], v[56:59]
    v_mfma_f32_16x16x32_bf16 v[60:63], a[100:103], v[92:95], v[60:63]
    v_mfma_f32_16x16x32_bf16 v[64:67], a[104:107], v[92:95], v[64:67]
    v_mfma_f32_16x16x32_bf16 v[68:71], a[108:111], v[92:95], v[68:71]
    s_waitcnt vmcnt(9)
    v_mfma_f32_16x16x32_bf16 v[116:119], a[92:95], a[28:31], 0
    v_mfma_f32_16x16x16_bf16 v[104:107], a[60:61], a[28:29], 0
    v_mfma_f32_16x16x16_bf16 v[108:111], a[62:63], a[30:31], 0
    ds_read_b64_tr_b16 a[96:97], v120 offset:24576
    ds_read_b64_tr_b16 a[98:99], v120 offset:26624
    ds_read_b64_tr_b16 a[100:101], v121 offset:24576
    ds_read_b64_tr_b16 a[102:103], v121 offset:26624
    ds_read_b64_tr_b16 a[104:105], v122 offset:24576
    ds_read_b64_tr_b16 a[106:107], v122 offset:26624
    ds_read_b64_tr_b16 a[108:109], v123 offset:24576
    ds_read_b64_tr_b16 a[110:111], v123 offset:26624
    v_cvt_pk_bf16_f32 v7, v112, v113
    v_lshlrev_b32 v112, 16, v7
    v_and_b32 v113, 4294901760, v7
    v_pk_add_f32 v[112:113], v[112:113], s[54:55]
    v_cvt_pk_bf16_f32 v7, v112, v113
    v_lshlrev_b32 v112, 16, v7
    v_and_b32 v113, 4294901760, v7
    v_rcp_f32 v114, v113
    v_rcp_f32 v112, v112
    s_nop 0
    v_pk_mul_f32 v[96:97], v[96:97], v[112:113] op_sel_hi:[1,0]
    v_pk_mul_f32 v[98:99], v[98:99], v[112:113] op_sel_hi:[1,0]
    v_cvt_pk_bf16_f32 v88, v96, v97
    v_cvt_pk_bf16_f32 v89, v98, v99
    v_pk_mul_f32 v[100:101], v[100:101], v[114:115] op_sel_hi:[1,0]
    v_pk_mul_f32 v[102:103], v[102:103], v[114:115] op_sel_hi:[1,0]
    v_cvt_pk_bf16_f32 v90, v100, v101
    v_cvt_pk_bf16_f32 v91, v102, v103
    s_waitcnt lgkmcnt(0)
    s_nop 0
    v_mfma_f32_16x16x32_bf16 v[56:59], a[96:99], v[88:91], v[56:59]
    v_mfma_f32_16x16x32_bf16 v[60:63], a[100:103], v[88:91], v[60:63]
    v_mfma_f32_16x16x32_bf16 v[64:67], a[104:107], v[88:91], v[64:67]
    v_mfma_f32_16x16x32_bf16 v[68:71], a[108:111], v[88:91], v[68:71]
    ds_read_b64_tr_b16 a[96:97], v120 offset:28672
    ds_read_b64_tr_b16 a[98:99], v120 offset:30720
    ds_read_b64_tr_b16 a[100:101], v121 offset:28672
    ds_read_b64_tr_b16 a[102:103], v121 offset:30720
    ds_read_b64_tr_b16 a[104:105], v122 offset:28672
    ds_read_b64_tr_b16 a[106:107], v122 offset:30720
    ds_read_b64_tr_b16 a[108:109], v123 offset:28672
    ds_read_b64_tr_b16 a[110:111], v123 offset:30720
    v_cvt_pk_bf16_f32 v7, v116, v117
    v_lshlrev_b32 v116, 16, v7
    v_and_b32 v117, 4294901760, v7
    v_pk_add_f32 v[116:117], v[116:117], s[54:55]
    v_cvt_pk_bf16_f32 v7, v116, v117
    v_lshlrev_b32 v116, 16, v7
    v_and_b32 v117, 4294901760, v7
    v_rcp_f32 v118, v117
    v_rcp_f32 v116, v116
    s_nop 0
    v_pk_mul_f32 v[104:105], v[104:105], v[116:117] op_sel_hi:[1,0]
    v_pk_mul_f32 v[106:107], v[106:107], v[116:117] op_sel_hi:[1,0]
    v_cvt_pk_bf16_f32 v92, v104, v105
    v_cvt_pk_bf16_f32 v93, v106, v107
    v_pk_mul_f32 v[108:109], v[108:109], v[118:119] op_sel_hi:[1,0]
    v_pk_mul_f32 v[110:111], v[110:111], v[118:119] op_sel_hi:[1,0]
    v_cvt_pk_bf16_f32 v94, v108, v109
    v_cvt_pk_bf16_f32 v95, v110, v111
    s_waitcnt lgkmcnt(0)
    s_nop 0
    v_mfma_f32_16x16x32_bf16 v[56:59], a[96:99], v[92:95], v[56:59]
    v_mfma_f32_16x16x32_bf16 v[60:63], a[100:103], v[92:95], v[60:63]
    v_mfma_f32_16x16x32_bf16 v[64:67], a[104:107], v[92:95], v[64:67]
    v_mfma_f32_16x16x32_bf16 v[68:71], a[108:111], v[92:95], v[68:71]
    s_barrier
    s_mul_i32 s39, s36, 2048
    s_add_u32 s39, s39, 65536
    v_add_u32 v124, s39, v4
    s_nop 2
    ds_write_b128 v124, v[64:67]
    ds_write_b128 v124, v[68:71] offset:1024
    s_xor_b32 s39, s36, 1
    s_mul_i32 s39, s39, 2048
    s_add_u32 s39, s39, 65536
    s_waitcnt lgkmcnt(0)
    s_barrier
    v_add_u32 v124, s39, v4
    ds_read_b128 v[96:99], v124
    ds_read_b128 v[100:103], v124 offset:1024
    s_waitcnt lgkmcnt(1)
    v_pk_add_f32 v[56:57], v[56:57], v[96:97]
    v_pk_add_f32 v[58:59], v[58:59], v[98:99]
    s_waitcnt lgkmcnt(0)
    v_pk_add_f32 v[60:61], v[60:61], v[100:101]
    v_pk_add_f32 v[62:63], v[62:63], v[102:103]
    s_waitcnt vmcnt(8)
    v_cvt_pk_bf16_f32 v7, v56, v57
    v_lshlrev_b32 v56, 16, v7
    v_and_b32 v57, 4294901760, v7
    v_lshlrev_b32 v26, 16, v80
    v_and_b32 v27, 4294901760, v80
    v_pk_add_f32 v[56:57], v[56:57], v[26:27]
    v_cvt_pk_bf16_f32 v128, v56, v57
    v_cvt_pk_bf16_f32 v7, v58, v59
    v_lshlrev_b32 v58, 16, v7
    v_and_b32 v59, 4294901760, v7
    v_lshlrev_b32 v26, 16, v81
    v_and_b32 v27, 4294901760, v81
    v_pk_add_f32 v[58:59], v[58:59], v[26:27]
    v_cvt_pk_bf16_f32 v129, v58, v59
    v_cvt_pk_bf16_f32 v7, v60, v61
    v_lshlrev_b32 v60, 16, v7
    v_and_b32 v61, 4294901760, v7
    v_lshlrev_b32 v26, 16, v82
    v_and_b32 v27, 4294901760, v82
    v_pk_add_f32 v[60:61], v[60:61], v[26:27]
    v_cvt_pk_bf16_f32 v130, v60, v61
    v_cvt_pk_bf16_f32 v7, v62, v63
    v_lshlrev_b32 v62, 16, v7
    v_and_b32 v63, 4294901760, v7
    v_lshlrev_b32 v26, 16, v83
    v_and_b32 v27, 4294901760, v83
    v_pk_add_f32 v[62:63], v[62:63], v[26:27]
    v_cvt_pk_bf16_f32 v131, v62, v63
    s_lshl_b32 s90, s63, 4
    s_add_u32 s90, s90, s65
    s_lshl_b32 s90, s90, 10
    s_add_u32 s90, s90, 0x800000
    buffer_store_dwordx4 v[128:131], v4, s[32:35], s90 offen sc1
    v_lshlrev_b32 v5, 16, v128
    v_and_b32 v6, 4294901760, v128
    v_add_f32 v132, v5, v6
    v_mul_f32 v133, v5, v5
    v_fmac_f32 v133, v6, v6
    v_lshlrev_b32 v5, 16, v129
    v_and_b32 v6, 4294901760, v129
    v_add_f32 v132, v132, v5
    v_add_f32 v132, v132, v6
    v_fmac_f32 v133, v5, v5
    v_fmac_f32 v133, v6, v6
    v_lshlrev_b32 v5, 16, v130
    v_and_b32 v6, 4294901760, v130
    v_add_f32 v132, v132, v5
    v_add_f32 v132, v132, v6
    v_fmac_f32 v133, v5, v5
    v_fmac_f32 v133, v6, v6
    v_lshlrev_b32 v5, 16, v131
    v_and_b32 v6, 4294901760, v131
    v_add_f32 v132, v132, v5
    v_add_f32 v132, v132, v6
    v_fmac_f32 v133, v5, v5
    v_fmac_f32 v133, v6, v6
    v_mov_b32 v5, v132
    v_mov_b32 v6, v133
    s_nop 0
    v_permlane32_swap_b32 v5, v132
    v_permlane32_swap_b32 v6, v133
    v_add_f32 v132, v132, v5
    v_add_f32 v133, v133, v6
    v_mov_b32 v5, v132
    v_mov_b32 v6, v133
    s_nop 0
    v_permlane16_swap_b32 v5, v132
    v_permlane16_swap_b32 v6, v133
    v_add_f32 v134, v132, v5
    v_add_f32 v135, v133, v6
    v_lshlrev_b32 v136, 7, v2
    v_mov_b32 v5, 0x7ff00000
    v_cmp_eq_u32 vcc, 0, v3
    s_nop 1
    v_cndmask_b32 v136, v5, v136, vcc
    s_lshl_b32 s91, s63, 11
    s_lshl_b32 s41, s65, 3
    s_add_u32 s91, s91, s41
    s_add_u32 s91, s91, 0x1b80000
    buffer_store_dwordx2 v[134:135], v136, s[32:35], s91 offen sc1
    v_lshlrev_b32 v58, 7, v2
    v_lshl_add_u32 v58, v3, 5, v58
    s_lshl_b32 s82, s61, 11
    s_add_u32 s82, s82, 0x1b80000
    s_mul_i32 s83, s61, 16
    s_mul_i32 s40, s62, 8
    s_add_u32 s83, s83, s40
    s_lshl_b32 s83, s83, 10
    s_add_u32 s83, s83, 0x800000
    s_add_u32 s84, s83, 4096
    s_xor_b32 s39, s61, 1
    s_mul_i32 s85, s39, 16
    s_mul_i32 s40, s62, 8
    s_add_u32 s85, s85, s40
    s_lshl_b32 s85, s85, 10
    s_add_u32 s85, s85, 0x800000
    s_add_u32 s86, s85, 4096
    s_waitcnt vmcnt(0)
    s_barrier
    buffer_atomic_add v9, v11, s[32:35], s44 offen sc1
    s_add_u32 m0, s79, 98304
    s_add_u32 s73, s78, 0
    buffer_load_dwordx4 v32, s[16:19], s73 offen lds
    s_add_u32 m0, s79, 99328
    s_add_u32 s73, s78, 0
    buffer_load_dwordx4 v33, s[16:19], s73 offen lds
    s_add_u32 m0, s79, 100352
    s_add_u32 s73, s78, 0
    buffer_load_dwordx4 v34, s[16:19], s73 offen lds
    s_add_u32 m0, s79, 122880
    s_add_u32 s73, s78, 917504
    buffer_load_dwordx4 v32, s[16:19], s73 offen lds
    s_add_u32 m0, s79, 123904
    s_add_u32 s73, s78, 917504
    buffer_load_dwordx4 v33, s[16:19], s73 offen lds
    s_add_u32 m0, s79, 124928
    s_add_u32 s73, s78, 917504
    buffer_load_dwordx4 v34, s[16:19], s73 offen lds
    s_mov_b32 s60, 0
    s_cmp_lg_u32 s36, 0
    s_nop 3
    s_cbranch_scc1 Linterleave_layers__linear_attn_block__dense_activation_silu__prompt_kernel_32
Linterleave_layers__linear_attn_block__dense_activation_silu__prompt_kernel_31:
    buffer_load_dword v13, v10, s[32:35], s44 offen sc1
    s_waitcnt vmcnt(0)
    v_readfirstlane_b32 s39, v13
    s_nop 4
    s_cmp_ge_u32 s39, 112
    s_cbranch_scc1 Linterleave_layers__linear_attn_block__dense_activation_silu__prompt_kernel_32
    s_sleep 2
    s_add_u32 s60, s60, 1
    s_cmp_lt_u32 s60, 0x40000
    s_cbranch_scc1 Linterleave_layers__linear_attn_block__dense_activation_silu__prompt_kernel_31
Linterleave_layers__linear_attn_block__dense_activation_silu__prompt_kernel_32:
    s_nop 3
    s_waitcnt vmcnt(0)
    s_barrier
    buffer_load_dwordx4 a[0:3], v4, s[32:35], s83 offen sc1
    buffer_load_dwordx4 a[32:35], v4, s[32:35], s85 offen sc1
    buffer_load_dwordx4 v[60:63], v58, s[32:35], s82 offen sc1
    buffer_load_dwordx4 v[64:67], v58, s[32:35], s82 offen offset:16 sc1
    buffer_load_dwordx4 a[4:7], v4, s[32:35], s83 offen offset:1024 sc1
    buffer_load_dwordx4 a[36:39], v4, s[32:35], s85 offen offset:1024 sc1
    buffer_load_dwordx4 a[8:11], v4, s[32:35], s83 offen offset:2048 sc1
    buffer_load_dwordx4 a[40:43], v4, s[32:35], s85 offen offset:2048 sc1
    buffer_load_dwordx4 a[12:15], v4, s[32:35], s83 offen offset:3072 sc1
    buffer_load_dwordx4 a[44:47], v4, s[32:35], s85 offen offset:3072 sc1
    s_waitcnt vmcnt(6)
    v_add_f32 v68, v60, v62
    v_add_f32 v69, v61, v63
    v_add_f32 v64, v64, v66
    v_add_f32 v65, v65, v67
    v_add_f32 v68, v68, v64
    v_add_f32 v69, v69, v65
    v_mov_b32 v5, v68
    v_mov_b32 v6, v69
    s_nop 0
    v_permlane32_swap_b32 v5, v68
    v_permlane32_swap_b32 v6, v69
    v_add_f32 v68, v68, v5
    v_add_f32 v69, v69, v6
    v_mov_b32 v5, v68
    v_mov_b32 v6, v69
    s_nop 0
    v_permlane16_swap_b32 v5, v68
    v_permlane16_swap_b32 v6, v69
    v_add_f32 v70, v68, v5
    v_add_f32 v71, v69, v6
    v_mul_f32 v70, 0x3b000000, v70
    v_mul_f32 v71, 0x3b000000, v71
    v_fma_f32 v71, -v70, v70, v71
    v_max_f32 v71, 0, v71
    v_cvt_pk_bf16_f32 v7, v70, v71
    v_lshlrev_b32 v70, 16, v7
    v_and_b32 v71, 4294901760, v7
    v_add_f32 v71, 0x3727c5ac, v71
    v_cvt_pk_bf16_f32 v7, v71, v71
    v_lshlrev_b32 v71, 16, v7
    v_sqrt_f32 v71, v71
    s_nop 0
    v_cvt_pk_bf16_f32 v7, v71, v71
    v_lshlrev_b32 v71, 16, v7
    v_rcp_f32 v71, v71
    v_sub_f32 v70, 0, v70
    v_mov_b32 v54, v70
    v_mov_b32 v56, v71
    s_lshl_b32 s39, s62, 15
    v_add_u32 v116, s39, v35
    v_add_u32 v117, s39, v36
    v_add_u32 v118, s39, v37
    v_add_u32 v119, s39, v38
    s_mul_i32 s39, s62, 24576
    s_add_u32 s39, s39, 98304
    v_add_u32 v120, s39, v45
    s_mul_i32 s87, s61, 56
    s_lshr_b32 s39, s43, 1
    s_mul_i32 s39, s39, 7
    s_add_u32 s87, s87, s39
    s_and_b32 s40, s43, 1
    s_add_u32 s88, s87, 6
    s_lshl_b32 s88, s88, 10
    s_lshl_b32 s39, s40, 3
    s_add_u32 s88, s88, s39
    s_add_u32 s88, s88, 0x1200000
    s_mul_i32 s39, s40, 3
    s_add_u32 s87, s87, s39
    s_lshl_b32 s87, s87, 10
    s_add_u32 s87, s87, 0x1200000
    ds_read_b64_tr_b16 a[64:65], v116
    ds_read_b64_tr_b16 a[66:67], v116 offset:2048
    ds_read_b64_tr_b16 a[68:69], v117
    ds_read_b64_tr_b16 a[70:71], v117 offset:2048
    ds_read_b64_tr_b16 a[72:73], v118
    ds_read_b64_tr_b16 a[74:75], v118 offset:2048
    ds_read_b64_tr_b16 a[76:77], v119
    ds_read_b64_tr_b16 a[78:79], v119 offset:2048
    ds_read_b64_tr_b16 a[80:81], v120
    ds_read_b64_tr_b16 a[82:83], v120 offset:1536
    ds_read_b64_tr_b16 a[84:85], v120 offset:32
    ds_read_b64_tr_b16 a[86:87], v120 offset:1568
    ds_read_b64_tr_b16 a[88:89], v120 offset:64
    ds_read_b64_tr_b16 a[90:91], v120 offset:1600
    buffer_load_dwordx4 a[16:19], v4, s[32:35], s84 offen sc1
    buffer_load_dwordx4 a[48:51], v4, s[32:35], s86 offen sc1
    s_waitcnt lgkmcnt(6)
    v_mfma_f32_16x16x32_bf16 v[60:63], a[64:67], a[0:3], 0
    ds_read_b64_tr_b16 a[96:97], v116 offset:4096
    v_mfma_f32_16x16x32_bf16 v[88:91], a[64:67], a[32:35], 0
    ds_read_b64_tr_b16 a[98:99], v116 offset:6144
    v_mfma_f32_16x16x32_bf16 v[64:67], a[68:71], a[0:3], 0
    ds_read_b64_tr_b16 a[100:101], v117 offset:4096
    v_mfma_f32_16x16x32_bf16 v[92:95], a[68:71], a[32:35], 0
    ds_read_b64_tr_b16 a[102:103], v117 offset:6144
    v_mfma_f32_16x16x32_bf16 v[68:71], a[72:75], a[0:3], 0
    ds_read_b64_tr_b16 a[104:105], v118 offset:4096
    v_mfma_f32_16x16x32_bf16 v[96:99], a[72:75], a[32:35], 0
    ds_read_b64_tr_b16 a[106:107], v118 offset:6144
    v_mfma_f32_16x16x32_bf16 v[72:75], a[76:79], a[0:3], 0
    ds_read_b64_tr_b16 a[108:109], v119 offset:4096
    v_mfma_f32_16x16x32_bf16 v[100:103], a[76:79], a[32:35], 0
    ds_read_b64_tr_b16 a[110:111], v119 offset:6144
    s_waitcnt lgkmcnt(8)
    v_mfma_f32_16x16x32_bf16 v[76:79], a[80:83], a[0:3], 0
    ds_read_b64_tr_b16 a[64:65], v120 offset:3072
    v_mfma_f32_16x16x32_bf16 v[104:107], a[80:83], a[32:35], 0
    ds_read_b64_tr_b16 a[66:67], v120 offset:4608
    v_mfma_f32_16x16x32_bf16 v[80:83], a[84:87], a[0:3], 0
    ds_read_b64_tr_b16 a[68:69], v120 offset:3104
    v_mfma_f32_16x16x32_bf16 v[108:111], a[84:87], a[32:35], 0
    ds_read_b64_tr_b16 a[70:71], v120 offset:4640
    v_mfma_f32_16x16x32_bf16 v[84:87], a[88:91], a[0:3], 0
    ds_read_b64_tr_b16 a[72:73], v120 offset:3136
    v_mfma_f32_16x16x32_bf16 v[112:115], a[88:91], a[32:35], 0
    ds_read_b64_tr_b16 a[74:75], v120 offset:4672
    s_waitcnt vmcnt(6)
    buffer_load_dwordx4 a[20:23], v4, s[32:35], s84 offen offset:1024 sc1
    buffer_load_dwordx4 a[52:55], v4, s[32:35], s86 offen offset:1024 sc1
    s_waitcnt lgkmcnt(6)
    v_mfma_f32_16x16x32_bf16 v[60:63], a[96:99], a[4:7], v[60:63]
    ds_read_b64_tr_b16 a[80:81], v116 offset:8192
    v_mfma_f32_16x16x32_bf16 v[88:91], a[96:99], a[36:39], v[88:91]
    ds_read_b64_tr_b16 a[82:83], v116 offset:10240
    v_mfma_f32_16x16x32_bf16 v[64:67], a[100:103], a[4:7], v[64:67]
    ds_read_b64_tr_b16 a[84:85], v117 offset:8192
    v_mfma_f32_16x16x32_bf16 v[92:95], a[100:103], a[36:39], v[92:95]
    ds_read_b64_tr_b16 a[86:87], v117 offset:10240
    v_mfma_f32_16x16x32_bf16 v[68:71], a[104:107], a[4:7], v[68:71]
    ds_read_b64_tr_b16 a[88:89], v118 offset:8192
    v_mfma_f32_16x16x32_bf16 v[96:99], a[104:107], a[36:39], v[96:99]
    ds_read_b64_tr_b16 a[90:91], v118 offset:10240
    v_mfma_f32_16x16x32_bf16 v[72:75], a[108:111], a[4:7], v[72:75]
    ds_read_b64_tr_b16 a[92:93], v119 offset:8192
    v_mfma_f32_16x16x32_bf16 v[100:103], a[108:111], a[36:39], v[100:103]
    ds_read_b64_tr_b16 a[94:95], v119 offset:10240
    s_waitcnt lgkmcnt(8)
    v_mfma_f32_16x16x32_bf16 v[76:79], a[64:67], a[4:7], v[76:79]
    ds_read_b64_tr_b16 a[96:97], v120 offset:6144
    v_mfma_f32_16x16x32_bf16 v[104:107], a[64:67], a[36:39], v[104:107]
    ds_read_b64_tr_b16 a[98:99], v120 offset:7680
    v_mfma_f32_16x16x32_bf16 v[80:83], a[68:71], a[4:7], v[80:83]
    ds_read_b64_tr_b16 a[100:101], v120 offset:6176
    v_mfma_f32_16x16x32_bf16 v[108:111], a[68:71], a[36:39], v[108:111]
    ds_read_b64_tr_b16 a[102:103], v120 offset:7712
    v_mfma_f32_16x16x32_bf16 v[84:87], a[72:75], a[4:7], v[84:87]
    ds_read_b64_tr_b16 a[104:105], v120 offset:6208
    v_mfma_f32_16x16x32_bf16 v[112:115], a[72:75], a[36:39], v[112:115]
    ds_read_b64_tr_b16 a[106:107], v120 offset:7744
    s_waitcnt vmcnt(6)
    buffer_load_dwordx4 a[24:27], v4, s[32:35], s84 offen offset:2048 sc1
    buffer_load_dwordx4 a[56:59], v4, s[32:35], s86 offen offset:2048 sc1
    s_waitcnt lgkmcnt(6)
    v_mfma_f32_16x16x32_bf16 v[60:63], a[80:83], a[8:11], v[60:63]
    ds_read_b64_tr_b16 a[64:65], v116 offset:12288
    v_mfma_f32_16x16x32_bf16 v[88:91], a[80:83], a[40:43], v[88:91]
    ds_read_b64_tr_b16 a[66:67], v116 offset:14336
    v_mfma_f32_16x16x32_bf16 v[64:67], a[84:87], a[8:11], v[64:67]
    ds_read_b64_tr_b16 a[68:69], v117 offset:12288
    v_mfma_f32_16x16x32_bf16 v[92:95], a[84:87], a[40:43], v[92:95]
    ds_read_b64_tr_b16 a[70:71], v117 offset:14336
    v_mfma_f32_16x16x32_bf16 v[68:71], a[88:91], a[8:11], v[68:71]
    ds_read_b64_tr_b16 a[72:73], v118 offset:12288
    v_mfma_f32_16x16x32_bf16 v[96:99], a[88:91], a[40:43], v[96:99]
    ds_read_b64_tr_b16 a[74:75], v118 offset:14336
    v_mfma_f32_16x16x32_bf16 v[72:75], a[92:95], a[8:11], v[72:75]
    ds_read_b64_tr_b16 a[76:77], v119 offset:12288
    v_mfma_f32_16x16x32_bf16 v[100:103], a[92:95], a[40:43], v[100:103]
    ds_read_b64_tr_b16 a[78:79], v119 offset:14336
    s_waitcnt lgkmcnt(8)
    v_mfma_f32_16x16x32_bf16 v[76:79], a[96:99], a[8:11], v[76:79]
    ds_read_b64_tr_b16 a[80:81], v120 offset:9216
    v_mfma_f32_16x16x32_bf16 v[104:107], a[96:99], a[40:43], v[104:107]
    ds_read_b64_tr_b16 a[82:83], v120 offset:10752
    v_mfma_f32_16x16x32_bf16 v[80:83], a[100:103], a[8:11], v[80:83]
    ds_read_b64_tr_b16 a[84:85], v120 offset:9248
    v_mfma_f32_16x16x32_bf16 v[108:111], a[100:103], a[40:43], v[108:111]
    ds_read_b64_tr_b16 a[86:87], v120 offset:10784
    v_mfma_f32_16x16x32_bf16 v[84:87], a[104:107], a[8:11], v[84:87]
    ds_read_b64_tr_b16 a[88:89], v120 offset:9280
    v_mfma_f32_16x16x32_bf16 v[112:115], a[104:107], a[40:43], v[112:115]
    ds_read_b64_tr_b16 a[90:91], v120 offset:10816
    s_waitcnt vmcnt(6)
    buffer_load_dwordx4 a[28:31], v4, s[32:35], s84 offen offset:3072 sc1
    buffer_load_dwordx4 a[60:63], v4, s[32:35], s86 offen offset:3072 sc1
    s_waitcnt lgkmcnt(6)
    v_mfma_f32_16x16x32_bf16 v[60:63], a[64:67], a[12:15], v[60:63]
    ds_read_b64_tr_b16 a[96:97], v116 offset:16384
    v_mfma_f32_16x16x32_bf16 v[88:91], a[64:67], a[44:47], v[88:91]
    ds_read_b64_tr_b16 a[98:99], v116 offset:18432
    v_mfma_f32_16x16x32_bf16 v[64:67], a[68:71], a[12:15], v[64:67]
    ds_read_b64_tr_b16 a[100:101], v117 offset:16384
    v_mfma_f32_16x16x32_bf16 v[92:95], a[68:71], a[44:47], v[92:95]
    ds_read_b64_tr_b16 a[102:103], v117 offset:18432
    v_mfma_f32_16x16x32_bf16 v[68:71], a[72:75], a[12:15], v[68:71]
    ds_read_b64_tr_b16 a[104:105], v118 offset:16384
    v_mfma_f32_16x16x32_bf16 v[96:99], a[72:75], a[44:47], v[96:99]
    ds_read_b64_tr_b16 a[106:107], v118 offset:18432
    v_mfma_f32_16x16x32_bf16 v[72:75], a[76:79], a[12:15], v[72:75]
    ds_read_b64_tr_b16 a[108:109], v119 offset:16384
    v_mfma_f32_16x16x32_bf16 v[100:103], a[76:79], a[44:47], v[100:103]
    ds_read_b64_tr_b16 a[110:111], v119 offset:18432
    s_waitcnt lgkmcnt(8)
    v_mfma_f32_16x16x32_bf16 v[76:79], a[80:83], a[12:15], v[76:79]
    ds_read_b64_tr_b16 a[64:65], v120 offset:12288
    v_mfma_f32_16x16x32_bf16 v[104:107], a[80:83], a[44:47], v[104:107]
    ds_read_b64_tr_b16 a[66:67], v120 offset:13824
    v_mfma_f32_16x16x32_bf16 v[80:83], a[84:87], a[12:15], v[80:83]
    ds_read_b64_tr_b16 a[68:69], v120 offset:12320
    v_mfma_f32_16x16x32_bf16 v[108:111], a[84:87], a[44:47], v[108:111]
    ds_read_b64_tr_b16 a[70:71], v120 offset:13856
    v_mfma_f32_16x16x32_bf16 v[84:87], a[88:91], a[12:15], v[84:87]
    ds_read_b64_tr_b16 a[72:73], v120 offset:12352
    v_mfma_f32_16x16x32_bf16 v[112:115], a[88:91], a[44:47], v[112:115]
    ds_read_b64_tr_b16 a[74:75], v120 offset:13888
    s_waitcnt vmcnt(6)
    s_waitcnt lgkmcnt(6)
    v_mfma_f32_16x16x32_bf16 v[60:63], a[96:99], a[16:19], v[60:63]
    ds_read_b64_tr_b16 a[80:81], v116 offset:20480
    v_mfma_f32_16x16x32_bf16 v[88:91], a[96:99], a[48:51], v[88:91]
    ds_read_b64_tr_b16 a[82:83], v116 offset:22528
    v_mfma_f32_16x16x32_bf16 v[64:67], a[100:103], a[16:19], v[64:67]
    ds_read_b64_tr_b16 a[84:85], v117 offset:20480
    v_mfma_f32_16x16x32_bf16 v[92:95], a[100:103], a[48:51], v[92:95]
    ds_read_b64_tr_b16 a[86:87], v117 offset:22528
    v_mfma_f32_16x16x32_bf16 v[68:71], a[104:107], a[16:19], v[68:71]
    ds_read_b64_tr_b16 a[88:89], v118 offset:20480
    v_mfma_f32_16x16x32_bf16 v[96:99], a[104:107], a[48:51], v[96:99]
    ds_read_b64_tr_b16 a[90:91], v118 offset:22528
    v_mfma_f32_16x16x32_bf16 v[72:75], a[108:111], a[16:19], v[72:75]
    ds_read_b64_tr_b16 a[92:93], v119 offset:20480
    v_mfma_f32_16x16x32_bf16 v[100:103], a[108:111], a[48:51], v[100:103]
    ds_read_b64_tr_b16 a[94:95], v119 offset:22528
    s_mul_i32 s59, s48, 7168
    buffer_load_dword v13, v25, s[20:23], s59 offen
    s_waitcnt lgkmcnt(8)
    v_mfma_f32_16x16x32_bf16 v[76:79], a[64:67], a[16:19], v[76:79]
    ds_read_b64_tr_b16 a[96:97], v120 offset:15360
    v_mfma_f32_16x16x32_bf16 v[104:107], a[64:67], a[48:51], v[104:107]
    ds_read_b64_tr_b16 a[98:99], v120 offset:16896
    v_mfma_f32_16x16x32_bf16 v[80:83], a[68:71], a[16:19], v[80:83]
    ds_read_b64_tr_b16 a[100:101], v120 offset:15392
    v_mfma_f32_16x16x32_bf16 v[108:111], a[68:71], a[48:51], v[108:111]
    ds_read_b64_tr_b16 a[102:103], v120 offset:16928
    v_mfma_f32_16x16x32_bf16 v[84:87], a[72:75], a[16:19], v[84:87]
    ds_read_b64_tr_b16 a[104:105], v120 offset:15424
    v_mfma_f32_16x16x32_bf16 v[112:115], a[72:75], a[48:51], v[112:115]
    ds_read_b64_tr_b16 a[106:107], v120 offset:16960
    s_waitcnt vmcnt(5)
    s_waitcnt lgkmcnt(6)
    v_mfma_f32_16x16x32_bf16 v[60:63], a[80:83], a[20:23], v[60:63]
    ds_read_b64_tr_b16 a[64:65], v116 offset:24576
    v_mfma_f32_16x16x32_bf16 v[88:91], a[80:83], a[52:55], v[88:91]
    ds_read_b64_tr_b16 a[66:67], v116 offset:26624
    v_mfma_f32_16x16x32_bf16 v[64:67], a[84:87], a[20:23], v[64:67]
    ds_read_b64_tr_b16 a[68:69], v117 offset:24576
    v_mfma_f32_16x16x32_bf16 v[92:95], a[84:87], a[52:55], v[92:95]
    ds_read_b64_tr_b16 a[70:71], v117 offset:26624
    v_mfma_f32_16x16x32_bf16 v[68:71], a[88:91], a[20:23], v[68:71]
    ds_read_b64_tr_b16 a[72:73], v118 offset:24576
    v_mfma_f32_16x16x32_bf16 v[96:99], a[88:91], a[52:55], v[96:99]
    ds_read_b64_tr_b16 a[74:75], v118 offset:26624
    v_mfma_f32_16x16x32_bf16 v[72:75], a[92:95], a[20:23], v[72:75]
    ds_read_b64_tr_b16 a[76:77], v119 offset:24576
    v_mfma_f32_16x16x32_bf16 v[100:103], a[92:95], a[52:55], v[100:103]
    ds_read_b64_tr_b16 a[78:79], v119 offset:26624
    s_waitcnt lgkmcnt(8)
    v_mfma_f32_16x16x32_bf16 v[76:79], a[96:99], a[20:23], v[76:79]
    ds_read_b64_tr_b16 a[80:81], v120 offset:18432
    v_mfma_f32_16x16x32_bf16 v[104:107], a[96:99], a[52:55], v[104:107]
    ds_read_b64_tr_b16 a[82:83], v120 offset:19968
    v_mfma_f32_16x16x32_bf16 v[80:83], a[100:103], a[20:23], v[80:83]
    ds_read_b64_tr_b16 a[84:85], v120 offset:18464
    v_mfma_f32_16x16x32_bf16 v[108:111], a[100:103], a[52:55], v[108:111]
    ds_read_b64_tr_b16 a[86:87], v120 offset:20000
    v_mfma_f32_16x16x32_bf16 v[84:87], a[104:107], a[20:23], v[84:87]
    ds_read_b64_tr_b16 a[88:89], v120 offset:18496
    v_mfma_f32_16x16x32_bf16 v[112:115], a[104:107], a[52:55], v[112:115]
    ds_read_b64_tr_b16 a[90:91], v120 offset:20032
    s_waitcnt vmcnt(3)
    s_waitcnt lgkmcnt(6)
    v_mfma_f32_16x16x32_bf16 v[60:63], a[64:67], a[24:27], v[60:63]
    ds_read_b64_tr_b16 a[96:97], v116 offset:28672
    v_mfma_f32_16x16x32_bf16 v[88:91], a[64:67], a[56:59], v[88:91]
    ds_read_b64_tr_b16 a[98:99], v116 offset:30720
    v_mfma_f32_16x16x32_bf16 v[64:67], a[68:71], a[24:27], v[64:67]
    ds_read_b64_tr_b16 a[100:101], v117 offset:28672
    v_mfma_f32_16x16x32_bf16 v[92:95], a[68:71], a[56:59], v[92:95]
    ds_read_b64_tr_b16 a[102:103], v117 offset:30720
    v_mfma_f32_16x16x32_bf16 v[68:71], a[72:75], a[24:27], v[68:71]
    ds_read_b64_tr_b16 a[104:105], v118 offset:28672
    v_mfma_f32_16x16x32_bf16 v[96:99], a[72:75], a[56:59], v[96:99]
    ds_read_b64_tr_b16 a[106:107], v118 offset:30720
    v_mfma_f32_16x16x32_bf16 v[72:75], a[76:79], a[24:27], v[72:75]
    ds_read_b64_tr_b16 a[108:109], v119 offset:28672
    v_mfma_f32_16x16x32_bf16 v[100:103], a[76:79], a[56:59], v[100:103]
    ds_read_b64_tr_b16 a[110:111], v119 offset:30720
    s_waitcnt lgkmcnt(8)
    v_mfma_f32_16x16x32_bf16 v[76:79], a[80:83], a[24:27], v[76:79]
    ds_read_b64_tr_b16 a[64:65], v120 offset:21504
    v_mfma_f32_16x16x32_bf16 v[104:107], a[80:83], a[56:59], v[104:107]
    ds_read_b64_tr_b16 a[66:67], v120 offset:23040
    v_mfma_f32_16x16x32_bf16 v[80:83], a[84:87], a[24:27], v[80:83]
    ds_read_b64_tr_b16 a[68:69], v120 offset:21536
    v_mfma_f32_16x16x32_bf16 v[108:111], a[84:87], a[56:59], v[108:111]
    ds_read_b64_tr_b16 a[70:71], v120 offset:23072
    v_mfma_f32_16x16x32_bf16 v[84:87], a[88:91], a[24:27], v[84:87]
    ds_read_b64_tr_b16 a[72:73], v120 offset:21568
    v_mfma_f32_16x16x32_bf16 v[112:115], a[88:91], a[56:59], v[112:115]
    ds_read_b64_tr_b16 a[74:75], v120 offset:23104
    s_waitcnt vmcnt(1)
    s_waitcnt lgkmcnt(6)
    v_mfma_f32_16x16x32_bf16 v[60:63], a[96:99], a[28:31], v[60:63]
    v_mfma_f32_16x16x32_bf16 v[88:91], a[96:99], a[60:63], v[88:91]
    v_mfma_f32_16x16x32_bf16 v[64:67], a[100:103], a[28:31], v[64:67]
    v_mfma_f32_16x16x32_bf16 v[92:95], a[100:103], a[60:63], v[92:95]
    v_mfma_f32_16x16x32_bf16 v[68:71], a[104:107], a[28:31], v[68:71]
    v_mfma_f32_16x16x32_bf16 v[96:99], a[104:107], a[60:63], v[96:99]
    v_mfma_f32_16x16x32_bf16 v[72:75], a[108:111], a[28:31], v[72:75]
    v_mfma_f32_16x16x32_bf16 v[100:103], a[108:111], a[60:63], v[100:103]
    s_waitcnt lgkmcnt(0)
    v_mfma_f32_16x16x32_bf16 v[76:79], a[64:67], a[28:31], v[76:79]
    v_mfma_f32_16x16x32_bf16 v[104:107], a[64:67], a[60:63], v[104:107]
    v_mfma_f32_16x16x32_bf16 v[80:83], a[68:71], a[28:31], v[80:83]
    v_mfma_f32_16x16x32_bf16 v[108:111], a[68:71], a[60:63], v[108:111]
    v_mfma_f32_16x16x32_bf16 v[84:87], a[72:75], a[28:31], v[84:87]
    v_mfma_f32_16x16x32_bf16 v[112:115], a[72:75], a[60:63], v[112:115]
    s_barrier
    s_mul_i32 s39, s36, 7168
    s_add_u32 s39, s39, 65536
    v_add_u32 v116, s39, v4
    ds_write_b128 v116, v[88:91]
    ds_write_b128 v116, v[92:95] offset:1024
    ds_write_b128 v116, v[96:99] offset:2048
    ds_write_b128 v116, v[100:103] offset:3072
    ds_write_b128 v116, v[104:107] offset:4096
    ds_write_b128 v116, v[108:111] offset:5120
    ds_write_b128 v116, v[112:115] offset:6144
    s_xor_b32 s39, s36, 1
    s_mul_i32 s39, s39, 7168
    s_add_u32 s39, s39, 65536
    s_waitcnt lgkmcnt(0)
    s_barrier
    v_add_u32 v116, s39, v4
    ds_read_b128 v[88:91], v116
    ds_read_b128 v[92:95], v116 offset:1024
    ds_read_b128 v[96:99], v116 offset:2048
    ds_read_b128 v[100:103], v116 offset:3072
    ds_read_b128 v[104:107], v116 offset:4096
    ds_read_b128 v[108:111], v116 offset:5120
    ds_read_b128 v[112:115], v116 offset:6144
    s_waitcnt lgkmcnt(6)
    v_pk_add_f32 v[60:61], v[60:61], v[88:89]
    v_pk_add_f32 v[62:63], v[62:63], v[90:91]
    s_waitcnt lgkmcnt(5)
    v_pk_add_f32 v[64:65], v[64:65], v[92:93]
    v_pk_add_f32 v[66:67], v[66:67], v[94:95]
    s_waitcnt lgkmcnt(4)
    v_pk_add_f32 v[68:69], v[68:69], v[96:97]
    v_pk_add_f32 v[70:71], v[70:71], v[98:99]
    s_waitcnt lgkmcnt(3)
    v_pk_add_f32 v[72:73], v[72:73], v[100:101]
    v_pk_add_f32 v[74:75], v[74:75], v[102:103]
    s_waitcnt lgkmcnt(2)
    v_pk_add_f32 v[76:77], v[76:77], v[104:105]
    v_pk_add_f32 v[78:79], v[78:79], v[106:107]
    s_waitcnt lgkmcnt(1)
    v_pk_add_f32 v[80:81], v[80:81], v[108:109]
    v_pk_add_f32 v[82:83], v[82:83], v[110:111]
    s_waitcnt lgkmcnt(0)
    v_pk_add_f32 v[84:85], v[84:85], v[112:113]
    v_pk_add_f32 v[86:87], v[86:87], v[114:115]
    v_add_u32 v8, 147840, v15
    ds_read_b128 v[88:91], v8
    ds_read_b128 v[92:95], v8 offset:64
    ds_read_b128 v[96:99], v8 offset:128
    ds_read_b128 v[100:103], v8 offset:192
    ds_read_b128 v[104:107], v8 offset:256
    ds_read_b128 v[108:111], v8 offset:320
    ds_read_b128 v[112:115], v8 offset:384
    s_waitcnt lgkmcnt(0)
    v_pk_fma_f32 v[60:61], v[88:89], v[54:55], v[60:61] op_sel_hi:[1,0,1]
    v_pk_mul_f32 v[60:61], v[60:61], v[56:57] op_sel_hi:[1,0]
    v_cvt_pk_bf16_f32 v7, v60, v61
    v_lshlrev_b32 v60, 16, v7
    v_and_b32 v61, 4294901760, v7
    v_pk_mul_f32 v[26:27], v[60:61], s[52:53]
    v_exp_f32 v26, v26
    v_exp_f32 v27, v27
    s_nop 0
    v_pk_add_f32 v[26:27], v[26:27], s[56:57]
    v_rcp_f32 v26, v26
    v_rcp_f32 v27, v27
    s_nop 0
    v_pk_mul_f32 v[60:61], v[60:61], v[26:27]
    v_cvt_pk_bf16_f32 v120, v60, v61
    v_pk_fma_f32 v[62:63], v[90:91], v[54:55], v[62:63] op_sel_hi:[1,0,1]
    v_pk_mul_f32 v[62:63], v[62:63], v[56:57] op_sel_hi:[1,0]
    v_cvt_pk_bf16_f32 v7, v62, v63
    v_lshlrev_b32 v62, 16, v7
    v_and_b32 v63, 4294901760, v7
    v_pk_mul_f32 v[26:27], v[62:63], s[52:53]
    v_exp_f32 v26, v26
    v_exp_f32 v27, v27
    s_nop 0
    v_pk_add_f32 v[26:27], v[26:27], s[56:57]
    v_rcp_f32 v26, v26
    v_rcp_f32 v27, v27
    s_nop 0
    v_pk_mul_f32 v[62:63], v[62:63], v[26:27]
    v_cvt_pk_bf16_f32 v121, v62, v63
    v_pk_fma_f32 v[64:65], v[92:93], v[54:55], v[64:65] op_sel_hi:[1,0,1]
    v_pk_mul_f32 v[64:65], v[64:65], v[56:57] op_sel_hi:[1,0]
    v_cvt_pk_bf16_f32 v7, v64, v65
    v_lshlrev_b32 v64, 16, v7
    v_and_b32 v65, 4294901760, v7
    v_pk_mul_f32 v[26:27], v[64:65], s[52:53]
    v_exp_f32 v26, v26
    v_exp_f32 v27, v27
    s_nop 0
    v_pk_add_f32 v[26:27], v[26:27], s[56:57]
    v_rcp_f32 v26, v26
    v_rcp_f32 v27, v27
    s_nop 0
    v_pk_mul_f32 v[64:65], v[64:65], v[26:27]
    v_cvt_pk_bf16_f32 v122, v64, v65
    v_pk_fma_f32 v[66:67], v[94:95], v[54:55], v[66:67] op_sel_hi:[1,0,1]
    v_pk_mul_f32 v[66:67], v[66:67], v[56:57] op_sel_hi:[1,0]
    v_cvt_pk_bf16_f32 v7, v66, v67
    v_lshlrev_b32 v66, 16, v7
    v_and_b32 v67, 4294901760, v7
    v_pk_mul_f32 v[26:27], v[66:67], s[52:53]
    v_exp_f32 v26, v26
    v_exp_f32 v27, v27
    s_nop 0
    v_pk_add_f32 v[26:27], v[26:27], s[56:57]
    v_rcp_f32 v26, v26
    v_rcp_f32 v27, v27
    s_nop 0
    v_pk_mul_f32 v[66:67], v[66:67], v[26:27]
    v_cvt_pk_bf16_f32 v123, v66, v67
    buffer_store_dwordx4 v[120:123], v4, s[32:35], s87 offen sc1
    v_pk_fma_f32 v[68:69], v[96:97], v[54:55], v[68:69] op_sel_hi:[1,0,1]
    v_pk_mul_f32 v[68:69], v[68:69], v[56:57] op_sel_hi:[1,0]
    v_cvt_pk_bf16_f32 v7, v68, v69
    v_lshlrev_b32 v68, 16, v7
    v_and_b32 v69, 4294901760, v7
    v_pk_mul_f32 v[26:27], v[68:69], s[52:53]
    v_exp_f32 v26, v26
    v_exp_f32 v27, v27
    s_nop 0
    v_pk_add_f32 v[26:27], v[26:27], s[56:57]
    v_rcp_f32 v26, v26
    v_rcp_f32 v27, v27
    s_nop 0
    v_pk_mul_f32 v[68:69], v[68:69], v[26:27]
    v_cvt_pk_bf16_f32 v124, v68, v69
    v_pk_fma_f32 v[70:71], v[98:99], v[54:55], v[70:71] op_sel_hi:[1,0,1]
    v_pk_mul_f32 v[70:71], v[70:71], v[56:57] op_sel_hi:[1,0]
    v_cvt_pk_bf16_f32 v7, v70, v71
    v_lshlrev_b32 v70, 16, v7
    v_and_b32 v71, 4294901760, v7
    v_pk_mul_f32 v[26:27], v[70:71], s[52:53]
    v_exp_f32 v26, v26
    v_exp_f32 v27, v27
    s_nop 0
    v_pk_add_f32 v[26:27], v[26:27], s[56:57]
    v_rcp_f32 v26, v26
    v_rcp_f32 v27, v27
    s_nop 0
    v_pk_mul_f32 v[70:71], v[70:71], v[26:27]
    v_cvt_pk_bf16_f32 v125, v70, v71
    v_pk_fma_f32 v[72:73], v[100:101], v[54:55], v[72:73] op_sel_hi:[1,0,1]
    v_pk_mul_f32 v[72:73], v[72:73], v[56:57] op_sel_hi:[1,0]
    v_cvt_pk_bf16_f32 v7, v72, v73
    v_lshlrev_b32 v72, 16, v7
    v_and_b32 v73, 4294901760, v7
    v_pk_mul_f32 v[26:27], v[72:73], s[52:53]
    v_exp_f32 v26, v26
    v_exp_f32 v27, v27
    s_nop 0
    v_pk_add_f32 v[26:27], v[26:27], s[56:57]
    v_rcp_f32 v26, v26
    v_rcp_f32 v27, v27
    s_nop 0
    v_pk_mul_f32 v[72:73], v[72:73], v[26:27]
    v_cvt_pk_bf16_f32 v126, v72, v73
    v_pk_fma_f32 v[74:75], v[102:103], v[54:55], v[74:75] op_sel_hi:[1,0,1]
    v_pk_mul_f32 v[74:75], v[74:75], v[56:57] op_sel_hi:[1,0]
    v_cvt_pk_bf16_f32 v7, v74, v75
    v_lshlrev_b32 v74, 16, v7
    v_and_b32 v75, 4294901760, v7
    v_pk_mul_f32 v[26:27], v[74:75], s[52:53]
    v_exp_f32 v26, v26
    v_exp_f32 v27, v27
    s_nop 0
    v_pk_add_f32 v[26:27], v[26:27], s[56:57]
    v_rcp_f32 v26, v26
    v_rcp_f32 v27, v27
    s_nop 0
    v_pk_mul_f32 v[74:75], v[74:75], v[26:27]
    v_cvt_pk_bf16_f32 v127, v74, v75
    buffer_store_dwordx4 v[124:127], v4, s[32:35], s87 offen offset:1024 sc1
    v_pk_fma_f32 v[76:77], v[104:105], v[54:55], v[76:77] op_sel_hi:[1,0,1]
    v_pk_mul_f32 v[76:77], v[76:77], v[56:57] op_sel_hi:[1,0]
    v_cvt_pk_bf16_f32 v7, v76, v77
    v_lshlrev_b32 v76, 16, v7
    v_and_b32 v77, 4294901760, v7
    v_pk_mul_f32 v[26:27], v[76:77], s[52:53]
    v_exp_f32 v26, v26
    v_exp_f32 v27, v27
    s_add_u32 m0, s69, 0
    s_add_u32 s73, s71, 0
    buffer_load_dwordx4 v30, s[20:23], s73 offen lds
    v_pk_add_f32 v[26:27], v[26:27], s[56:57]
    v_rcp_f32 v26, v26
    v_rcp_f32 v27, v27
    s_nop 0
    v_pk_mul_f32 v[76:77], v[76:77], v[26:27]
    v_cvt_pk_bf16_f32 v120, v76, v77
    v_pk_fma_f32 v[78:79], v[106:107], v[54:55], v[78:79] op_sel_hi:[1,0,1]
    v_pk_mul_f32 v[78:79], v[78:79], v[56:57] op_sel_hi:[1,0]
    v_cvt_pk_bf16_f32 v7, v78, v79
    s_add_u32 m0, s69, 1024
    s_add_u32 s73, s71, 8192
    buffer_load_dwordx4 v30, s[20:23], s73 offen lds
    v_lshlrev_b32 v78, 16, v7
    v_and_b32 v79, 4294901760, v7
    v_pk_mul_f32 v[26:27], v[78:79], s[52:53]
    v_exp_f32 v26, v26
    v_exp_f32 v27, v27
    s_nop 0
    v_pk_add_f32 v[26:27], v[26:27], s[56:57]
    v_rcp_f32 v26, v26
    v_rcp_f32 v27, v27
    s_add_u32 m0, s69, 16384
    s_add_u32 s73, s71, 32768
    buffer_load_dwordx4 v30, s[20:23], s73 offen lds
    v_pk_mul_f32 v[78:79], v[78:79], v[26:27]
    v_cvt_pk_bf16_f32 v121, v78, v79
    s_waitcnt vmcnt(3)
    s_barrier
    buffer_atomic_add v9, v11, s[32:35], s44 offen sc1
    v_pk_fma_f32 v[80:81], v[108:109], v[54:55], v[80:81] op_sel_hi:[1,0,1]
    v_pk_mul_f32 v[80:81], v[80:81], v[56:57] op_sel_hi:[1,0]
    v_cvt_pk_bf16_f32 v7, v80, v81
    v_lshlrev_b32 v80, 16, v7
    v_and_b32 v81, 4294901760, v7
    v_pk_mul_f32 v[26:27], v[80:81], s[52:53]
    s_add_u32 m0, s69, 17408
    s_add_u32 s73, s71, 40960
    buffer_load_dwordx4 v30, s[20:23], s73 offen lds
    v_exp_f32 v26, v26
    v_exp_f32 v27, v27
    s_nop 0
    v_pk_add_f32 v[26:27], v[26:27], s[56:57]
    v_rcp_f32 v26, v26
    v_rcp_f32 v27, v27
    s_nop 0
    v_pk_mul_f32 v[80:81], v[80:81], v[26:27]
    v_cvt_pk_bf16_f32 v122, v80, v81
    v_pk_fma_f32 v[82:83], v[110:111], v[54:55], v[82:83] op_sel_hi:[1,0,1]
    s_add_u32 m0, s69, 32768
    s_add_u32 s73, s71, 114688
    buffer_load_dwordx4 v30, s[20:23], s73 offen lds
    v_pk_mul_f32 v[82:83], v[82:83], v[56:57] op_sel_hi:[1,0]
    v_cvt_pk_bf16_f32 v7, v82, v83
    v_lshlrev_b32 v82, 16, v7
    v_and_b32 v83, 4294901760, v7
    v_pk_mul_f32 v[26:27], v[82:83], s[52:53]
    v_exp_f32 v26, v26
    v_exp_f32 v27, v27
    s_nop 0
    v_pk_add_f32 v[26:27], v[26:27], s[56:57]
    s_add_u32 m0, s69, 33792
    s_add_u32 s73, s71, 122880
    buffer_load_dwordx4 v30, s[20:23], s73 offen lds
    v_rcp_f32 v26, v26
    v_rcp_f32 v27, v27
    s_nop 0
    v_pk_mul_f32 v[82:83], v[82:83], v[26:27]
    v_cvt_pk_bf16_f32 v123, v82, v83
    buffer_store_dwordx4 v[120:123], v4, s[32:35], s87 offen offset:2048 sc1
    v_pk_fma_f32 v[84:85], v[112:113], v[54:55], v[84:85] op_sel_hi:[1,0,1]
    v_pk_mul_f32 v[84:85], v[84:85], v[56:57] op_sel_hi:[1,0]
    v_cvt_pk_bf16_f32 v7, v84, v85
    v_lshlrev_b32 v84, 16, v7
    s_add_u32 m0, s69, 49152
    s_add_u32 s73, s71, 147456
    buffer_load_dwordx4 v30, s[20:23], s73 offen lds
    v_and_b32 v85, 4294901760, v7
    v_pk_mul_f32 v[26:27], v[84:85], s[52:53]
    v_exp_f32 v26, v26
    v_exp_f32 v27, v27
    s_nop 0
    v_pk_add_f32 v[26:27], v[26:27], s[56:57]
    v_rcp_f32 v26, v26
    v_rcp_f32 v27, v27
    s_nop 0
    v_pk_mul_f32 v[84:85], v[84:85], v[26:27]
    s_add_u32 m0, s69, 50176
    s_add_u32 s73, s71, 155648
    buffer_load_dwordx4 v30, s[20:23], s73 offen lds
    v_cvt_pk_bf16_f32 v124, v84, v85
    v_pk_fma_f32 v[86:87], v[114:115], v[54:55], v[86:87] op_sel_hi:[1,0,1]
    v_pk_mul_f32 v[86:87], v[86:87], v[56:57] op_sel_hi:[1,0]
    v_cvt_pk_bf16_f32 v7, v86, v87
    v_lshlrev_b32 v86, 16, v7
    v_and_b32 v87, 4294901760, v7
    v_pk_mul_f32 v[26:27], v[86:87], s[52:53]
    v_exp_f32 v26, v26
    v_exp_f32 v27, v27
    s_nop 0
    v_pk_add_f32 v[26:27], v[26:27], s[56:57]
    v_rcp_f32 v26, v26
    v_rcp_f32 v27, v27
    s_nop 0
    v_pk_mul_f32 v[86:87], v[86:87], v[26:27]
    v_cvt_pk_bf16_f32 v125, v86, v87
    buffer_store_dwordx2 v[124:125], v4, s[32:35], s88 offen sc1
    s_mul_i32 s82, s63, 56
    s_mul_i32 s40, s70, 14
    s_add_u32 s82, s82, s40
    s_lshl_b32 s82, s82, 10
    s_add_u32 s82, s82, 0x1200000
    s_xor_b32 s39, s63, 1
    s_mul_i32 s83, s39, 56
    s_mul_i32 s40, s70, 14
    s_add_u32 s83, s83, s40
    s_lshl_b32 s83, s83, 10
    s_add_u32 s83, s83, 0x1200000
    s_mov_b32 s60, 0
    s_cmp_lg_u32 s36, 0
    s_nop 3
    s_cbranch_scc1 Linterleave_layers__linear_attn_block__dense_activation_silu__prompt_kernel_34
Linterleave_layers__linear_attn_block__dense_activation_silu__prompt_kernel_33:
    buffer_load_dword v13, v10, s[32:35], s44 offen sc1
    s_waitcnt vmcnt(0)
    v_readfirstlane_b32 s39, v13
    s_nop 4
    s_cmp_ge_u32 s39, 128
    s_cbranch_scc1 Linterleave_layers__linear_attn_block__dense_activation_silu__prompt_kernel_34
    s_sleep 2
    s_add_u32 s60, s60, 1
    s_cmp_lt_u32 s60, 0x40000
    s_cbranch_scc1 Linterleave_layers__linear_attn_block__dense_activation_silu__prompt_kernel_33
Linterleave_layers__linear_attn_block__dense_activation_silu__prompt_kernel_34:
    s_nop 3
    s_waitcnt vmcnt(1)
    s_barrier
    s_add_u32 s59, s82, 0
    buffer_load_dwordx4 a[0:3], v4, s[32:35], s59 offen sc1
    s_add_u32 s59, s83, 0
    buffer_load_dwordx4 a[56:59], v4, s[32:35], s59 offen sc1
    s_add_u32 s59, s82, 1024
    buffer_load_dwordx4 a[4:7], v4, s[32:35], s59 offen sc1
    s_add_u32 s59, s83, 1024
    buffer_load_dwordx4 a[60:63], v4, s[32:35], s59 offen sc1
    s_add_u32 s59, s82, 3072
    buffer_load_dwordx4 a[8:11], v4, s[32:35], s59 offen sc1
    s_add_u32 s59, s83, 3072
    buffer_load_dwordx4 a[64:67], v4, s[32:35], s59 offen sc1
    s_lshl_b32 s84, s63, 4
    s_add_u32 s84, s84, s65
    s_lshl_b32 s84, s84, 10
    s_add_u32 s84, s84, 0x800000
    buffer_load_dwordx4 v[56:59], v4, s[32:35], s84 offen sc1
    s_lshl_b32 s39, s70, 12
    v_add_u32 v124, s39, v39
    v_add_u32 v128, 65536, v124
    v_add_u32 v132, 131072, v124
    v_add_u32 v125, s39, v40
    v_add_u32 v129, 65536, v125
    v_add_u32 v133, 131072, v125
    v_add_u32 v126, s39, v41
    v_add_u32 v130, 65536, v126
    v_add_u32 v134, 131072, v126
    v_add_u32 v127, s39, v42
    v_add_u32 v131, 65536, v127
    v_add_u32 v135, 131072, v127
    s_add_u32 m0, s69, 81920
    s_add_u32 s73, s71, 229376
    buffer_load_dwordx4 v30, s[20:23], s73 offen lds
    s_add_u32 m0, s69, 82944
    s_add_u32 s73, s71, 237568
    buffer_load_dwordx4 v30, s[20:23], s73 offen lds
    s_add_u32 m0, s69, 98304
    s_add_u32 s73, s71, 262144
    buffer_load_dwordx4 v30, s[20:23], s73 offen lds
    s_add_u32 m0, s69, 99328
    s_add_u32 s73, s71, 270336
    buffer_load_dwordx4 v30, s[20:23], s73 offen lds
    ds_read_b64_tr_b16 v[92:93], v124
    ds_read_b64_tr_b16 v[94:95], v124 offset:2048
    ds_read_b64_tr_b16 v[96:97], v125
    ds_read_b64_tr_b16 v[98:99], v125 offset:2048
    ds_read_b64_tr_b16 v[100:101], v126
    ds_read_b64_tr_b16 v[102:103], v126 offset:2048
    ds_read_b64_tr_b16 v[104:105], v127
    ds_read_b64_tr_b16 v[106:107], v127 offset:2048
    s_waitcnt vmcnt(9)
    s_add_u32 s59, s82, 4096
    buffer_load_dwordx4 a[12:15], v4, s[32:35], s59 offen sc1
    s_add_u32 s59, s83, 4096
    buffer_load_dwordx4 a[68:71], v4, s[32:35], s59 offen sc1
    s_waitcnt lgkmcnt(0)
    v_mfma_f32_16x16x32_bf16 v[60:63], v[92:95], a[0:3], 0
    ds_read_b64_tr_b16 v[108:109], v124 offset:16384
    v_mfma_f32_16x16x32_bf16 v[76:79], v[92:95], a[56:59], 0
    ds_read_b64_tr_b16 v[110:111], v124 offset:18432
    v_mfma_f32_16x16x32_bf16 v[64:67], v[96:99], a[0:3], 0
    ds_read_b64_tr_b16 v[112:113], v125 offset:16384
    v_mfma_f32_16x16x32_bf16 v[80:83], v[96:99], a[56:59], 0
    ds_read_b64_tr_b16 v[114:115], v125 offset:18432
    v_mfma_f32_16x16x32_bf16 v[68:71], v[100:103], a[0:3], 0
    ds_read_b64_tr_b16 v[116:117], v126 offset:16384
    v_mfma_f32_16x16x32_bf16 v[84:87], v[100:103], a[56:59], 0
    ds_read_b64_tr_b16 v[118:119], v126 offset:18432
    v_mfma_f32_16x16x32_bf16 v[72:75], v[104:107], a[0:3], 0
    ds_read_b64_tr_b16 v[120:121], v127 offset:16384
    v_mfma_f32_16x16x32_bf16 v[88:91], v[104:107], a[56:59], 0
    ds_read_b64_tr_b16 v[122:123], v127 offset:18432
    s_add_u32 m0, s69, 114688
    s_add_u32 s73, s71, 344064
    buffer_load_dwordx4 v30, s[20:23], s73 offen lds
    s_add_u32 m0, s69, 115712
    s_add_u32 s73, s71, 352256
    buffer_load_dwordx4 v30, s[20:23], s73 offen lds
    s_barrier
    buffer_atomic_add v9, v11, s[32:35], s44 offen sc1
    s_waitcnt vmcnt(12)
    s_add_u32 s59, s82, 7168
    buffer_load_dwordx4 a[16:19], v4, s[32:35], s59 offen sc1
    s_add_u32 s59, s83, 7168
    buffer_load_dwordx4 a[72:75], v4, s[32:35], s59 offen sc1
    s_waitcnt lgkmcnt(0)
    v_mfma_f32_16x16x32_bf16 v[60:63], v[108:111], a[4:7], v[60:63]
    ds_read_b64_tr_b16 v[92:93], v124 offset:32768
    v_mfma_f32_16x16x32_bf16 v[76:79], v[108:111], a[60:63], v[76:79]
    ds_read_b64_tr_b16 v[94:95], v124 offset:34816
    v_mfma_f32_16x16x32_bf16 v[64:67], v[112:115], a[4:7], v[64:67]
    ds_read_b64_tr_b16 v[96:97], v125 offset:32768
    v_mfma_f32_16x16x32_bf16 v[80:83], v[112:115], a[60:63], v[80:83]
    ds_read_b64_tr_b16 v[98:99], v125 offset:34816
    v_mfma_f32_16x16x32_bf16 v[68:71], v[116:119], a[4:7], v[68:71]
    ds_read_b64_tr_b16 v[100:101], v126 offset:32768
    v_mfma_f32_16x16x32_bf16 v[84:87], v[116:119], a[60:63], v[84:87]
    ds_read_b64_tr_b16 v[102:103], v126 offset:34816
    v_mfma_f32_16x16x32_bf16 v[72:75], v[120:123], a[4:7], v[72:75]
    ds_read_b64_tr_b16 v[104:105], v127 offset:32768
    v_mfma_f32_16x16x32_bf16 v[88:91], v[120:123], a[60:63], v[88:91]
    ds_read_b64_tr_b16 v[106:107], v127 offset:34816
    s_add_u32 m0, s69, 131072
    s_add_u32 s73, s71, 376832
    buffer_load_dwordx4 v30, s[20:23], s73 offen lds
    s_add_u32 m0, s69, 132096
    s_add_u32 s73, s71, 385024
    buffer_load_dwordx4 v30, s[20:23], s73 offen lds
    s_waitcnt vmcnt(14)
    s_add_u32 s59, s82, 8192
    buffer_load_dwordx4 a[20:23], v4, s[32:35], s59 offen sc1
    s_add_u32 s59, s83, 8192
    buffer_load_dwordx4 a[76:79], v4, s[32:35], s59 offen sc1
    s_waitcnt lgkmcnt(0)
    v_mfma_f32_16x16x32_bf16 v[60:63], v[92:95], a[8:11], v[60:63]
    ds_read_b64_tr_b16 v[108:109], v124 offset:49152
    v_mfma_f32_16x16x32_bf16 v[76:79], v[92:95], a[64:67], v[76:79]
    ds_read_b64_tr_b16 v[110:111], v124 offset:51200
    v_mfma_f32_16x16x32_bf16 v[64:67], v[96:99], a[8:11], v[64:67]
    ds_read_b64_tr_b16 v[112:113], v125 offset:49152
    v_mfma_f32_16x16x32_bf16 v[80:83], v[96:99], a[64:67], v[80:83]
    ds_read_b64_tr_b16 v[114:115], v125 offset:51200
    v_mfma_f32_16x16x32_bf16 v[68:71], v[100:103], a[8:11], v[68:71]
    ds_read_b64_tr_b16 v[116:117], v126 offset:49152
    v_mfma_f32_16x16x32_bf16 v[84:87], v[100:103], a[64:67], v[84:87]
    ds_read_b64_tr_b16 v[118:119], v126 offset:51200
    v_mfma_f32_16x16x32_bf16 v[72:75], v[104:107], a[8:11], v[72:75]
    ds_read_b64_tr_b16 v[120:121], v127 offset:49152
    v_mfma_f32_16x16x32_bf16 v[88:91], v[104:107], a[64:67], v[88:91]
    ds_read_b64_tr_b16 v[122:123], v127 offset:51200
    s_add_u32 m0, s69, 65536
    s_add_u32 s73, s71, 65536
    buffer_load_dwordx4 v30, s[20:23], s73 offen lds
    s_add_u32 m0, s69, 66560
    s_add_u32 s73, s71, 73728
    buffer_load_dwordx4 v30, s[20:23], s73 offen lds
    s_waitcnt vmcnt(13)
    s_barrier
    s_waitcnt vmcnt(11)
    s_add_u32 s59, s82, 10240
    buffer_load_dwordx4 a[24:27], v4, s[32:35], s59 offen sc1
    s_add_u32 s59, s83, 10240
    buffer_load_dwordx4 a[80:83], v4, s[32:35], s59 offen sc1
    s_waitcnt lgkmcnt(0)
    v_mfma_f32_16x16x32_bf16 v[60:63], v[108:111], a[12:15], v[60:63]
    ds_read_b64_tr_b16 v[92:93], v128 offset:16384
    v_mfma_f32_16x16x32_bf16 v[76:79], v[108:111], a[68:71], v[76:79]
    ds_read_b64_tr_b16 v[94:95], v128 offset:18432
    v_mfma_f32_16x16x32_bf16 v[64:67], v[112:115], a[12:15], v[64:67]
    ds_read_b64_tr_b16 v[96:97], v129 offset:16384
    v_mfma_f32_16x16x32_bf16 v[80:83], v[112:115], a[68:71], v[80:83]
    ds_read_b64_tr_b16 v[98:99], v129 offset:18432
    v_mfma_f32_16x16x32_bf16 v[68:71], v[116:119], a[12:15], v[68:71]
    ds_read_b64_tr_b16 v[100:101], v130 offset:16384
    v_mfma_f32_16x16x32_bf16 v[84:87], v[116:119], a[68:71], v[84:87]
    ds_read_b64_tr_b16 v[102:103], v130 offset:18432
    v_mfma_f32_16x16x32_bf16 v[72:75], v[120:123], a[12:15], v[72:75]
    ds_read_b64_tr_b16 v[104:105], v131 offset:16384
    v_mfma_f32_16x16x32_bf16 v[88:91], v[120:123], a[68:71], v[88:91]
    ds_read_b64_tr_b16 v[106:107], v131 offset:18432
    s_barrier
    s_waitcnt vmcnt(8)
    s_add_u32 s59, s82, 11264
    buffer_load_dwordx4 a[28:31], v4, s[32:35], s59 offen sc1
    s_add_u32 s59, s83, 11264
    buffer_load_dwordx4 a[84:87], v4, s[32:35], s59 offen sc1
    s_waitcnt lgkmcnt(0)
    v_mfma_f32_16x16x32_bf16 v[60:63], v[92:95], a[16:19], v[60:63]
    ds_read_b64_tr_b16 v[108:109], v128 offset:32768
    v_mfma_f32_16x16x32_bf16 v[76:79], v[92:95], a[72:75], v[76:79]
    ds_read_b64_tr_b16 v[110:111], v128 offset:34816
    v_mfma_f32_16x16x32_bf16 v[64:67], v[96:99], a[16:19], v[64:67]
    ds_read_b64_tr_b16 v[112:113], v129 offset:32768
    v_mfma_f32_16x16x32_bf16 v[80:83], v[96:99], a[72:75], v[80:83]
    ds_read_b64_tr_b16 v[114:115], v129 offset:34816
    v_mfma_f32_16x16x32_bf16 v[68:71], v[100:103], a[16:19], v[68:71]
    ds_read_b64_tr_b16 v[116:117], v130 offset:32768
    v_mfma_f32_16x16x32_bf16 v[84:87], v[100:103], a[72:75], v[84:87]
    ds_read_b64_tr_b16 v[118:119], v130 offset:34816
    v_mfma_f32_16x16x32_bf16 v[72:75], v[104:107], a[16:19], v[72:75]
    ds_read_b64_tr_b16 v[120:121], v131 offset:32768
    v_mfma_f32_16x16x32_bf16 v[88:91], v[104:107], a[72:75], v[88:91]
    ds_read_b64_tr_b16 v[122:123], v131 offset:34816
    s_add_u32 m0, s69, 0
    s_add_u32 s73, s71, 180224
    buffer_load_dwordx4 v30, s[20:23], s73 offen lds
    s_add_u32 m0, s69, 1024
    s_add_u32 s73, s71, 188416
    buffer_load_dwordx4 v30, s[20:23], s73 offen lds
    s_waitcnt vmcnt(6)
    s_barrier
    s_mov_b32 s60, 0
    s_cmp_lg_u32 s36, 0
    s_nop 3
    s_cbranch_scc1 Linterleave_layers__linear_attn_block__dense_activation_silu__prompt_kernel_36
Linterleave_layers__linear_attn_block__dense_activation_silu__prompt_kernel_35:
    buffer_load_dword v13, v10, s[32:35], s44 offen sc1
    s_waitcnt vmcnt(0)
    v_readfirstlane_b32 s39, v13
    s_nop 4
    s_cmp_ge_u32 s39, 144
    s_cbranch_scc1 Linterleave_layers__linear_attn_block__dense_activation_silu__prompt_kernel_36
    s_sleep 2
    s_add_u32 s60, s60, 1
    s_cmp_lt_u32 s60, 0x40000
    s_cbranch_scc1 Linterleave_layers__linear_attn_block__dense_activation_silu__prompt_kernel_35
Linterleave_layers__linear_attn_block__dense_activation_silu__prompt_kernel_36:
    s_nop 3
    s_barrier
    s_add_u32 s59, s82, 2048
    buffer_load_dwordx4 a[32:35], v4, s[32:35], s59 offen sc1
    s_add_u32 s59, s83, 2048
    buffer_load_dwordx4 a[88:91], v4, s[32:35], s59 offen sc1
    s_waitcnt lgkmcnt(0)
    v_mfma_f32_16x16x32_bf16 v[60:63], v[108:111], a[20:23], v[60:63]
    ds_read_b64_tr_b16 v[92:93], v128 offset:49152
    v_mfma_f32_16x16x32_bf16 v[76:79], v[108:111], a[76:79], v[76:79]
    ds_read_b64_tr_b16 v[94:95], v128 offset:51200
    v_mfma_f32_16x16x32_bf16 v[64:67], v[112:115], a[20:23], v[64:67]
    ds_read_b64_tr_b16 v[96:97], v129 offset:49152
    v_mfma_f32_16x16x32_bf16 v[80:83], v[112:115], a[76:79], v[80:83]
    ds_read_b64_tr_b16 v[98:99], v129 offset:51200
    v_mfma_f32_16x16x32_bf16 v[68:71], v[116:119], a[20:23], v[68:71]
    ds_read_b64_tr_b16 v[100:101], v130 offset:49152
    v_mfma_f32_16x16x32_bf16 v[84:87], v[116:119], a[76:79], v[84:87]
    ds_read_b64_tr_b16 v[102:103], v130 offset:51200
    v_mfma_f32_16x16x32_bf16 v[72:75], v[120:123], a[20:23], v[72:75]
    ds_read_b64_tr_b16 v[104:105], v131 offset:49152
    v_mfma_f32_16x16x32_bf16 v[88:91], v[120:123], a[76:79], v[88:91]
    ds_read_b64_tr_b16 v[106:107], v131 offset:51200
    s_add_u32 m0, s69, 16384
    s_add_u32 s73, s72, 98304
    buffer_load_dwordx4 v30, s[20:23], s73 offen lds
    s_add_u32 m0, s69, 17408
    s_add_u32 s73, s72, 106496
    buffer_load_dwordx4 v30, s[20:23], s73 offen lds
    s_waitcnt vmcnt(8)
    s_add_u32 s59, s82, 5120
    buffer_load_dwordx4 a[36:39], v4, s[32:35], s59 offen sc1
    s_add_u32 s59, s83, 5120
    buffer_load_dwordx4 a[92:95], v4, s[32:35], s59 offen sc1
    s_waitcnt lgkmcnt(0)
    v_mfma_f32_16x16x32_bf16 v[60:63], v[92:95], a[24:27], v[60:63]
    ds_read_b64_tr_b16 v[108:109], v132
    v_mfma_f32_16x16x32_bf16 v[76:79], v[92:95], a[80:83], v[76:79]
    ds_read_b64_tr_b16 v[110:111], v132 offset:2048
    v_mfma_f32_16x16x32_bf16 v[64:67], v[96:99], a[24:27], v[64:67]
    ds_read_b64_tr_b16 v[112:113], v133
    v_mfma_f32_16x16x32_bf16 v[80:83], v[96:99], a[80:83], v[80:83]
    ds_read_b64_tr_b16 v[114:115], v133 offset:2048
    v_mfma_f32_16x16x32_bf16 v[68:71], v[100:103], a[24:27], v[68:71]
    ds_read_b64_tr_b16 v[116:117], v134
    v_mfma_f32_16x16x32_bf16 v[84:87], v[100:103], a[80:83], v[84:87]
    ds_read_b64_tr_b16 v[118:119], v134 offset:2048
    v_mfma_f32_16x16x32_bf16 v[72:75], v[104:107], a[24:27], v[72:75]
    ds_read_b64_tr_b16 v[120:121], v135
    v_mfma_f32_16x16x32_bf16 v[88:91], v[104:107], a[80:83], v[88:91]
    ds_read_b64_tr_b16 v[122:123], v135 offset:2048
    s_add_u32 m0, s69, 32768
    s_add_u32 s73, s71, 294912
    buffer_load_dwordx4 v30, s[20:23], s73 offen lds
    s_add_u32 m0, s69, 33792
    s_add_u32 s73, s71, 303104
    buffer_load_dwordx4 v30, s[20:23], s73 offen lds
    s_waitcnt vmcnt(10)
    s_add_u32 s59, s82, 6144
    buffer_load_dwordx4 a[40:43], v4, s[32:35], s59 offen sc1
    s_add_u32 s59, s83, 6144
    buffer_load_dwordx4 a[96:99], v4, s[32:35], s59 offen sc1
    s_waitcnt lgkmcnt(0)
    v_mfma_f32_16x16x32_bf16 v[60:63], v[108:111], a[28:31], v[60:63]
    ds_read_b64_tr_b16 v[92:93], v128
    v_mfma_f32_16x16x32_bf16 v[76:79], v[108:111], a[84:87], v[76:79]
    ds_read_b64_tr_b16 v[94:95], v128 offset:2048
    v_mfma_f32_16x16x32_bf16 v[64:67], v[112:115], a[28:31], v[64:67]
    ds_read_b64_tr_b16 v[96:97], v129
    v_mfma_f32_16x16x32_bf16 v[80:83], v[112:115], a[84:87], v[80:83]
    ds_read_b64_tr_b16 v[98:99], v129 offset:2048
    v_mfma_f32_16x16x32_bf16 v[68:71], v[116:119], a[28:31], v[68:71]
    ds_read_b64_tr_b16 v[100:101], v130
    v_mfma_f32_16x16x32_bf16 v[84:87], v[116:119], a[84:87], v[84:87]
    ds_read_b64_tr_b16 v[102:103], v130 offset:2048
    v_mfma_f32_16x16x32_bf16 v[72:75], v[120:123], a[28:31], v[72:75]
    ds_read_b64_tr_b16 v[104:105], v131
    v_mfma_f32_16x16x32_bf16 v[88:91], v[120:123], a[84:87], v[88:91]
    ds_read_b64_tr_b16 v[106:107], v131 offset:2048
    s_add_u32 m0, s69, 49152
    s_add_u32 s73, s71, 409600
    buffer_load_dwordx4 v30, s[20:23], s73 offen lds
    s_add_u32 m0, s69, 50176
    s_add_u32 s73, s71, 417792
    buffer_load_dwordx4 v30, s[20:23], s73 offen lds
    s_waitcnt vmcnt(8)
    s_barrier
    s_add_u32 s59, s82, 9216
    buffer_load_dwordx4 a[44:47], v4, s[32:35], s59 offen sc1
    s_add_u32 s59, s83, 9216
    buffer_load_dwordx4 a[100:103], v4, s[32:35], s59 offen sc1
    s_waitcnt lgkmcnt(0)
    v_mfma_f32_16x16x32_bf16 v[60:63], v[92:95], a[32:35], v[60:63]
    ds_read_b64_tr_b16 v[108:109], v124
    v_mfma_f32_16x16x32_bf16 v[76:79], v[92:95], a[88:91], v[76:79]
    ds_read_b64_tr_b16 v[110:111], v124 offset:2048
    v_mfma_f32_16x16x32_bf16 v[64:67], v[96:99], a[32:35], v[64:67]
    ds_read_b64_tr_b16 v[112:113], v125
    v_mfma_f32_16x16x32_bf16 v[80:83], v[96:99], a[88:91], v[80:83]
    ds_read_b64_tr_b16 v[114:115], v125 offset:2048
    v_mfma_f32_16x16x32_bf16 v[68:71], v[100:103], a[32:35], v[68:71]
    ds_read_b64_tr_b16 v[116:117], v126
    v_mfma_f32_16x16x32_bf16 v[84:87], v[100:103], a[88:91], v[84:87]
    ds_read_b64_tr_b16 v[118:119], v126 offset:2048
    v_mfma_f32_16x16x32_bf16 v[72:75], v[104:107], a[32:35], v[72:75]
    ds_read_b64_tr_b16 v[120:121], v127
    v_mfma_f32_16x16x32_bf16 v[88:91], v[104:107], a[88:91], v[88:91]
    ds_read_b64_tr_b16 v[122:123], v127 offset:2048
    s_barrier
    s_waitcnt vmcnt(8)
    s_add_u32 s59, s82, 12288
    buffer_load_dwordx4 a[48:51], v4, s[32:35], s59 offen sc1
    s_add_u32 s59, s83, 12288
    buffer_load_dwordx4 a[104:107], v4, s[32:35], s59 offen sc1
    s_waitcnt lgkmcnt(0)
    v_mfma_f32_16x16x32_bf16 v[60:63], v[108:111], a[36:39], v[60:63]
    ds_read_b64_tr_b16 v[92:93], v124 offset:16384
    v_mfma_f32_16x16x32_bf16 v[76:79], v[108:111], a[92:95], v[76:79]
    ds_read_b64_tr_b16 v[94:95], v124 offset:18432
    v_mfma_f32_16x16x32_bf16 v[64:67], v[112:115], a[36:39], v[64:67]
    ds_read_b64_tr_b16 v[96:97], v125 offset:16384
    v_mfma_f32_16x16x32_bf16 v[80:83], v[112:115], a[92:95], v[80:83]
    ds_read_b64_tr_b16 v[98:99], v125 offset:18432
    v_mfma_f32_16x16x32_bf16 v[68:71], v[116:119], a[36:39], v[68:71]
    ds_read_b64_tr_b16 v[100:101], v126 offset:16384
    v_mfma_f32_16x16x32_bf16 v[84:87], v[116:119], a[92:95], v[84:87]
    ds_read_b64_tr_b16 v[102:103], v126 offset:18432
    v_mfma_f32_16x16x32_bf16 v[72:75], v[120:123], a[36:39], v[72:75]
    ds_read_b64_tr_b16 v[104:105], v127 offset:16384
    v_mfma_f32_16x16x32_bf16 v[88:91], v[120:123], a[92:95], v[88:91]
    ds_read_b64_tr_b16 v[106:107], v127 offset:18432
    s_add_u32 m0, s69, 65536
    s_add_u32 s73, s72, 327680
    buffer_load_dwordx4 v30, s[20:23], s73 offen lds
    s_add_u32 m0, s69, 66560
    s_add_u32 s73, s72, 335872
    buffer_load_dwordx4 v30, s[20:23], s73 offen lds
    s_waitcnt vmcnt(6)
    s_barrier
    s_add_u32 s59, s82, 13312
    buffer_load_dwordx4 a[52:55], v4, s[32:35], s59 offen sc1
    s_add_u32 s59, s83, 13312
    buffer_load_dwordx4 a[108:111], v4, s[32:35], s59 offen sc1
    s_waitcnt lgkmcnt(0)
    v_mfma_f32_16x16x32_bf16 v[60:63], v[92:95], a[40:43], v[60:63]
    ds_read_b64_tr_b16 v[108:109], v124 offset:32768
    v_mfma_f32_16x16x32_bf16 v[76:79], v[92:95], a[96:99], v[76:79]
    ds_read_b64_tr_b16 v[110:111], v124 offset:34816
    v_mfma_f32_16x16x32_bf16 v[64:67], v[96:99], a[40:43], v[64:67]
    ds_read_b64_tr_b16 v[112:113], v125 offset:32768
    v_mfma_f32_16x16x32_bf16 v[80:83], v[96:99], a[96:99], v[80:83]
    ds_read_b64_tr_b16 v[114:115], v125 offset:34816
    v_mfma_f32_16x16x32_bf16 v[68:71], v[100:103], a[40:43], v[68:71]
    ds_read_b64_tr_b16 v[116:117], v126 offset:32768
    v_mfma_f32_16x16x32_bf16 v[84:87], v[100:103], a[96:99], v[84:87]
    ds_read_b64_tr_b16 v[118:119], v126 offset:34816
    v_mfma_f32_16x16x32_bf16 v[72:75], v[104:107], a[40:43], v[72:75]
    ds_read_b64_tr_b16 v[120:121], v127 offset:32768
    v_mfma_f32_16x16x32_bf16 v[88:91], v[104:107], a[96:99], v[88:91]
    ds_read_b64_tr_b16 v[122:123], v127 offset:34816
    s_waitcnt vmcnt(6)
    s_waitcnt lgkmcnt(0)
    v_mfma_f32_16x16x32_bf16 v[60:63], v[108:111], a[44:47], v[60:63]
    ds_read_b64_tr_b16 v[92:93], v124 offset:49152
    v_mfma_f32_16x16x32_bf16 v[76:79], v[108:111], a[100:103], v[76:79]
    ds_read_b64_tr_b16 v[94:95], v124 offset:51200
    v_mfma_f32_16x16x32_bf16 v[64:67], v[112:115], a[44:47], v[64:67]
    ds_read_b64_tr_b16 v[96:97], v125 offset:49152
    v_mfma_f32_16x16x32_bf16 v[80:83], v[112:115], a[100:103], v[80:83]
    ds_read_b64_tr_b16 v[98:99], v125 offset:51200
    v_mfma_f32_16x16x32_bf16 v[68:71], v[116:119], a[44:47], v[68:71]
    ds_read_b64_tr_b16 v[100:101], v126 offset:49152
    v_mfma_f32_16x16x32_bf16 v[84:87], v[116:119], a[100:103], v[84:87]
    ds_read_b64_tr_b16 v[102:103], v126 offset:51200
    v_mfma_f32_16x16x32_bf16 v[72:75], v[120:123], a[44:47], v[72:75]
    ds_read_b64_tr_b16 v[104:105], v127 offset:49152
    v_mfma_f32_16x16x32_bf16 v[88:91], v[120:123], a[100:103], v[88:91]
    ds_read_b64_tr_b16 v[106:107], v127 offset:51200
    s_waitcnt vmcnt(2)
    s_barrier
    s_waitcnt lgkmcnt(0)
    v_mfma_f32_16x16x32_bf16 v[60:63], v[92:95], a[48:51], v[60:63]
    ds_read_b64_tr_b16 v[108:109], v128
    v_mfma_f32_16x16x32_bf16 v[76:79], v[92:95], a[104:107], v[76:79]
    ds_read_b64_tr_b16 v[110:111], v128 offset:2048
    v_mfma_f32_16x16x32_bf16 v[64:67], v[96:99], a[48:51], v[64:67]
    ds_read_b64_tr_b16 v[112:113], v129
    v_mfma_f32_16x16x32_bf16 v[80:83], v[96:99], a[104:107], v[80:83]
    ds_read_b64_tr_b16 v[114:115], v129 offset:2048
    v_mfma_f32_16x16x32_bf16 v[68:71], v[100:103], a[48:51], v[68:71]
    ds_read_b64_tr_b16 v[116:117], v130
    v_mfma_f32_16x16x32_bf16 v[84:87], v[100:103], a[104:107], v[84:87]
    ds_read_b64_tr_b16 v[118:119], v130 offset:2048
    v_mfma_f32_16x16x32_bf16 v[72:75], v[104:107], a[48:51], v[72:75]
    ds_read_b64_tr_b16 v[120:121], v131
    v_mfma_f32_16x16x32_bf16 v[88:91], v[104:107], a[104:107], v[88:91]
    ds_read_b64_tr_b16 v[122:123], v131 offset:2048
    s_waitcnt vmcnt(0)
    s_waitcnt lgkmcnt(0)
    v_mfma_f32_16x16x32_bf16 v[60:63], v[108:111], a[52:55], v[60:63]
    v_mfma_f32_16x16x32_bf16 v[76:79], v[108:111], a[108:111], v[76:79]
    v_mfma_f32_16x16x32_bf16 v[64:67], v[112:115], a[52:55], v[64:67]
    v_mfma_f32_16x16x32_bf16 v[80:83], v[112:115], a[108:111], v[80:83]
    v_mfma_f32_16x16x32_bf16 v[68:71], v[116:119], a[52:55], v[68:71]
    v_mfma_f32_16x16x32_bf16 v[84:87], v[116:119], a[108:111], v[84:87]
    v_mfma_f32_16x16x32_bf16 v[72:75], v[120:123], a[52:55], v[72:75]
    v_mfma_f32_16x16x32_bf16 v[88:91], v[120:123], a[108:111], v[88:91]
    s_barrier
    s_xor_b32 s39, s36, 1
    s_mul_i32 s39, s39, 6144
    s_add_u32 s39, s39, 32768
    v_add_u32 v124, s39, v4
    ds_write_b128 v124, v[68:71]
    s_nop 0
    ds_write_b128 v124, v[72:75] offset:1024
    s_xor_b32 s39, s36, 2
    s_mul_i32 s39, s39, 6144
    s_add_u32 s39, s39, 34816
    v_add_u32 v124, s39, v4
    ds_write_b128 v124, v[76:79]
    ds_write_b128 v124, v[80:83] offset:1024
    s_xor_b32 s39, s36, 3
    s_mul_i32 s39, s39, 6144
    s_add_u32 s39, s39, 36864
    v_add_u32 v124, s39, v4
    ds_write_b128 v124, v[84:87]
    ds_write_b128 v124, v[88:91] offset:1024
    s_mul_i32 s39, s36, 6144
    s_add_u32 s39, s39, 32768
    s_waitcnt lgkmcnt(0)
    s_barrier
    v_add_u32 v124, s39, v4
    ds_read_b128 v[92:95], v124
    ds_read_b128 v[96:99], v124 offset:1024
    ds_read_b128 v[100:103], v124 offset:2048
    ds_read_b128 v[104:107], v124 offset:3072
    ds_read_b128 v[108:111], v124 offset:4096
    ds_read_b128 v[112:115], v124 offset:5120
    s_waitcnt lgkmcnt(5)
    v_pk_add_f32 v[60:61], v[60:61], v[92:93]
    v_pk_add_f32 v[62:63], v[62:63], v[94:95]
    s_waitcnt lgkmcnt(4)
    v_pk_add_f32 v[64:65], v[64:65], v[96:97]
    v_pk_add_f32 v[66:67], v[66:67], v[98:99]
    s_waitcnt lgkmcnt(3)
    v_pk_add_f32 v[60:61], v[60:61], v[100:101]
    v_pk_add_f32 v[62:63], v[62:63], v[102:103]
    s_waitcnt lgkmcnt(2)
    v_pk_add_f32 v[64:65], v[64:65], v[104:105]
    v_pk_add_f32 v[66:67], v[66:67], v[106:107]
    s_waitcnt lgkmcnt(1)
    v_pk_add_f32 v[60:61], v[60:61], v[108:109]
    v_pk_add_f32 v[62:63], v[62:63], v[110:111]
    s_waitcnt lgkmcnt(0)
    v_pk_add_f32 v[64:65], v[64:65], v[112:113]
    v_pk_add_f32 v[66:67], v[66:67], v[114:115]
    v_cvt_pk_bf16_f32 v7, v60, v61
    v_lshlrev_b32 v60, 16, v7
    v_and_b32 v61, 4294901760, v7
    v_lshlrev_b32 v26, 16, v56
    v_and_b32 v27, 4294901760, v56
    v_pk_add_f32 v[60:61], v[60:61], v[26:27]
    v_cvt_pk_bf16_f32 v128, v60, v61
    v_cvt_pk_bf16_f32 v7, v62, v63
    v_lshlrev_b32 v62, 16, v7
    v_and_b32 v63, 4294901760, v7
    v_lshlrev_b32 v26, 16, v57
    v_and_b32 v27, 4294901760, v57
    v_pk_add_f32 v[62:63], v[62:63], v[26:27]
    v_cvt_pk_bf16_f32 v129, v62, v63
    v_cvt_pk_bf16_f32 v7, v64, v65
    v_lshlrev_b32 v64, 16, v7
    v_and_b32 v65, 4294901760, v7
    v_lshlrev_b32 v26, 16, v58
    v_and_b32 v27, 4294901760, v58
    v_pk_add_f32 v[64:65], v[64:65], v[26:27]
    v_cvt_pk_bf16_f32 v130, v64, v65
    v_cvt_pk_bf16_f32 v7, v66, v67
    v_lshlrev_b32 v66, 16, v7
    v_and_b32 v67, 4294901760, v7
    v_lshlrev_b32 v26, 16, v59
    v_and_b32 v27, 4294901760, v59
    v_pk_add_f32 v[66:67], v[66:67], v[26:27]
    v_cvt_pk_bf16_f32 v131, v66, v67
    v_lshlrev_b32 v132, 10, v2
    v_lshl_add_u32 v132, v3, 3, v132
    s_lshl_b32 s85, s63, 14
    s_lshl_b32 s39, s65, 6
    s_add_u32 s85, s85, s39
    buffer_store_dwordx2 v[128:129], v132, s[24:27], s85 offen
    buffer_store_dwordx2 v[130:131], v132, s[24:27], s85 offen offset:32
Lend_main:
    s_endpgm
.section .rodata,"a"
.p2align 6
.amdhsa_kernel interleave_layers__linear_attn_block__dense_activation_silu__prompt_kernel
  .amdhsa_next_free_vgpr 252
  .amdhsa_next_free_sgpr 102
  .amdhsa_accum_offset 140
  .amdhsa_group_segment_fixed_size 0
  .amdhsa_kernarg_size 72
  .amdhsa_user_sgpr_count 2
  .amdhsa_user_sgpr_kernarg_segment_ptr 1
  .amdhsa_system_sgpr_workgroup_id_x 1
.end_amdhsa_kernel
```
